```python
import torch

def _softmax(x, axis=-1):
    return torch.softmax(x, dim=axis)
def _gelu(x):
    return torch.nn.functional.gelu(x, approximate="tanh")
def _silu(x):
    return torch.nn.functional.silu(x)
def _sigmoid(x):
    return torch.sigmoid(x)
def _layernorm(x, axis=-1, eps=1e-5):
    m = x.mean(dim=axis, keepdim=True)
    v = x.var(dim=axis, keepdim=True, unbiased=False)
    return (x - m) / torch.sqrt(v + eps)
def _scatter_add(tgt, idx, src, axis=0):
    return tgt.clone().index_add_(axis, idx, src)
def _segment_sum(src, seg, n):
    out = torch.zeros((n,) + src.shape[1:], dtype=src.dtype)
    return out.index_add_(0, seg, src)
def _pad(x, pw):
    flat = tuple(v for pair in reversed(pw) for v in pair)
    return torch.nn.functional.pad(x, flat)

kernel_name = 'parallel_sum__softmax_full_mha__glu_gated_geglu__prompt'

def setup_inputs():

    _w = (lambda a: (lambda t: t.to(torch.bfloat16) if t.is_floating_point() else t)(torch.as_tensor(a)))
    def _A_setup():
        B, S, D = 1, 2048, 512
        return {
            "x": _w((lambda *s: torch.randn(*s, dtype=torch.bfloat16) * 0.05)(B, S, D)),
            "wqkv": _w((lambda *s: torch.randn(*s, dtype=torch.bfloat16) * 0.05)(D, 3 * D)),
            "wo": _w((lambda *s: torch.randn(*s, dtype=torch.bfloat16) * 0.05)(D, D)),
        }
    _A_in = _A_setup()

    def _B_setup():
        B, S, Dm, Df = 1, 2048, 512, 1792
        return {
            "x": _w((lambda *s: torch.randn(*s, dtype=torch.bfloat16) * 0.05)(B, S, Dm)),
            "w_gate": _w((lambda *s: torch.randn(*s, dtype=torch.bfloat16) * 0.4)(Dm, Df) * (Dm ** -0.5)),
            "w_up": _w((lambda *s: torch.randn(*s, dtype=torch.bfloat16) * 0.4)(Dm, Df) * (Dm ** -0.5)),
            "w_down": _w((lambda *s: torch.randn(*s, dtype=torch.bfloat16) * 0.4)(Df, Dm) * (Df ** -0.5)),
        }
    _B_in = _B_setup()

    return {
        "A_x": _A_in["x"],
        "A_wqkv": _A_in["wqkv"],
        "A_wo": _A_in["wo"],
        "B_x": _B_in["x"],
        "B_w_gate": _B_in["w_gate"],
        "B_w_up": _B_in["w_up"],
        "B_w_down": _B_in["w_down"],
    }

def reference(A_x, A_wqkv, A_wo, B_x, B_w_gate, B_w_up, B_w_down):
    def _A_ref(x, wqkv, wo):
        B, S, D = x.shape
        H = 32; Dh = D // H
        qkv = (lambda x, *d: x.permute(*d))((x @ wqkv).reshape(B, S, 3, H, Dh), 2, 0, 3, 1, 4)
        q, k, v = qkv[0], qkv[1], qkv[2]
        scale = Dh ** -0.5
        scores = torch.einsum("bhqd,bhkd->bhqk", q, k) * scale
        p = _softmax(scores, axis=-1)
        o = torch.einsum("bhqk,bhkd->bhqd", p, v)
        return (lambda x, *d: x.permute(*d))(o, 0, 2, 1, 3).reshape(B, S, D) @ wo

    def _B_ref(x, w_gate, w_up, w_down):
        g = torch.einsum("bsd,df->bsf", x, w_gate)
        u = torch.einsum("bsd,df->bsf", x, w_up)
        h = _gelu(g) * u
        return torch.einsum("bsf,fd->bsd", h, w_down)

    x = A_x
    xn = _layernorm(x, axis=-1)
    return x + _A_ref(xn, A_wqkv, A_wo) + _B_ref(xn, B_w_gate, B_w_up, B_w_down)
```

```asm
; @launch grid=(256,1,1) block=(512,1,1) lds=163840
.amdgcn_target "amdgcn-amd-amdhsa--gfx950"
.text
.globl parallel_sum__softmax_full_mha__glu_gated_geglu__prompt_kernel
.p2align 8
.type parallel_sum__softmax_full_mha__glu_gated_geglu__prompt_kernel,@function
parallel_sum__softmax_full_mha__glu_gated_geglu__prompt_kernel:
    s_cmp_ge_u32 s2, 256
    s_cbranch_scc1 K_exit0
    s_load_dwordx8 s[36:43], s[0:1], 0
    s_load_dwordx8 s[44:51], s[0:1], 32
    s_load_dwordx4 s[56:59], s[0:1], 64
    v_lshrrev_b32 v2, 6, v0
    v_and_b32 v1, 63, v0
    v_readfirstlane_b32 s32, v2
    s_and_b32 s33, s2, 3
    s_lshl_b32 s33, s33, 2
    s_bfe_u32 s35, s2, 0x20003
    s_add_u32 s33, s33, s35
    s_bfe_u32 s35, s2, 0x10002
    s_lshr_b32 s34, s2, 5
    s_cmp_lt_u32 s34, 2
    s_cbranch_scc1 K1_typeB
    s_mul_i32 s35, s35, 6
    s_add_u32 s34, s34, s35
    s_sub_u32 s34, s34, 2
    s_cmp_lg_u32 s32, 4
    s_cbranch_scc1 K1a_c0
    s_getpc_b64 s[98:99]
K1a_pc:
    s_and_b32 s72, s33, 1
    s_lshl_b32 s72, s72, 13
    v_lshl_add_u32 v44, v1, 7, s72
    v_min_u32 v44, K1a_end-K1a_pc, v44
    global_load_dword v31, v44, s[98:99]
K1a_c0:
    v_lshrrev_b32 v40, 3, v1
    v_and_b32 v41, 7, v1
    v_lshrrev_b32 v42, 1, v40
    v_xor_b32 v43, v41, v42
    v_lshlrev_b32 v43, 4, v43
    v_lshl_add_u32 v106, v40, 10, v43
    v_xor_b32 v107, 64, v106
    v_add_u32 v107, 7168, v107
    v_add_u32 v108, 14336, v106
    v_add_u32 v109, 14336, v107
    s_and_b32 s35, s32, 3
    s_lshr_b32 s3, s32, 2
    s_lshl_b32 s75, s33, 2
    s_add_u32 s75, s75, s35
    s_lshl_b32 s98, s75, 15
    s_mul_i32 s94, s35, 40960
    s_lshl_b32 s72, s3, 14
    s_add_u32 s71, s94, s72
    s_add_u32 s71, s71, 16384
    s_lshl_b32 s72, s3, 12
    s_add_u32 s70, s94, s72
    s_lshr_b32 s97, s2, 5
    s_lshl_b32 s99, s3, 1
    s_xor_b32 s99, s99, s35
    s_add_u32 s77, s99, s97
    s_xor_b32 s78, s99, 1
    s_add_u32 s78, s78, s97
    s_and_b32 s77, s77, 7
    s_and_b32 s78, s78, 7
    s_lshl_b32 s77, s77, 7
    s_lshl_b32 s78, s78, 7
    s_add_u32 s77, s77, s98
    s_add_u32 s78, s78, s98
    s_mov_b32 s6, 2097152
    s_mov_b32 s7, 0x00020000
    s_waitcnt lgkmcnt(0)
    s_mov_b32 s4, s36
    s_mov_b32 s5, s37
    s_add_u32 m0, s71, 0
    s_nop 0
    buffer_load_dwordx4 v106, s[4:7], s77 offen offset:0 lds
    buffer_load_dwordx4 v107, s[4:7], s77 offen offset:1024 lds
    buffer_load_dwordx4 v108, s[4:7], s77 offen offset:2048 lds
    buffer_load_dwordx4 v109, s[4:7], s77 offen offset:3072 lds
    s_add_u32 m0, s71, 4096
    s_nop 0
    buffer_load_dwordx4 v106, s[4:7], s78 offen offset:0 lds
    v_mul_u32_u24 v77, 3072, v1
    v_mul_u32_u24 v76, 3584, v1
    v_add_u32 v77, 4096, v77
    v_add_u32 v76, 4096, v76
    s_and_b32 s74, s33, 3
    s_add_u32 s72, s97, s35
    s_lshl_b32 s72, s72, 1
    s_add_u32 s72, s72, s3
    s_and_b32 s72, s72, 15
    s_xor_b32 s73, s72, 8
    s_mul_i32 s94, s72, 114688
    s_mul_i32 s95, s73, 114688
    s_mul_i32 s72, s72, 98304
    s_mul_i32 s73, s73, 98304
    s_cmp_ge_u32 s34, 4
    s_cselect_b32 s81, 4, 0
    s_add_u32 s81, s81, s34
    s_lshl_b32 s96, s81, 7
    s_add_u32 s60, s72, s96
    s_add_u32 s62, s73, s96
    s_lshl_b32 s96, s34, 8
    s_add_u32 s61, s94, s96
    s_add_u32 s63, s95, s96
    s_mov_b32 s64, s61
    s_mov_b32 s65, s63
    s_add_u32 s66, s61, 128
    s_add_u32 s67, s63, 128
    s_mov_b32 s68, s66
    s_mov_b32 s69, s67
    s_mul_i32 s95, s33, 98304
    s_sub_u32 s95, s95, s72
    s_mul_i32 s96, s33, 114688
    s_sub_u32 s96, s96, s94
    s_add_u32 s84, s60, s95
    s_add_u32 s85, s61, s96
    s_add_u32 s86, s64, s96
    s_add_u32 s79, s66, s96
    s_mov_b32 s80, s79
    s_and_b32 s73, s33, 3
    s_add_u32 s73, s73, s97
    s_and_b32 s73, s73, 7
    s_mul_i32 s73, s73, 196608
    s_sub_u32 s94, s60, s72
    s_add_u32 s94, s94, s73
    s_waitcnt lgkmcnt(0)
    s_sub_u32 s16, s38, 4096
    s_subb_u32 s17, s39, 0
    s_mov_b32 s18, 1576960
    s_mov_b32 s19, 0x00020000
    s_sub_u32 s8, s44, 4096
    s_subb_u32 s9, s45, 0
    s_mov_b32 s10, 1839104
    s_mov_b32 s11, 0x00020000
    s_sub_u32 s12, s46, 4096
    s_subb_u32 s13, s47, 0
    s_mov_b32 s14, 1839104
    s_mov_b32 s15, 0x00020000
    v_lshrrev_b32 v69, 3, v1
    v_bfe_u32 v70, v1, 4, 1
    v_lshlrev_b32 v70, 2, v70
    v_xor_b32 v70, v70, v1
    v_and_b32 v70, 7, v70
    v_lshlrev_b32 v70, 4, v70
    v_mul_u32_u24 v69, 3072, v69
    v_add_u32 v71, v69, v70
    s_xor_b32 s72, s74, 0
    s_mul_i32 s72, s72, 24576
    s_add_u32 s72, s72, 4096
    v_add_u32 v68, s72, v71
    s_xor_b32 s72, s74, 1
    s_mul_i32 s72, s72, 24576
    s_add_u32 s72, s72, 3072
    v_add_u32 v69, s72, v71
    s_xor_b32 s72, s74, 2
    s_mul_i32 s72, s72, 24576
    s_add_u32 s72, s72, 2048
    v_add_u32 v70, s72, v71
    s_xor_b32 s72, s74, 3
    s_mul_i32 s72, s72, 24576
    s_add_u32 s72, s72, 1024
    v_add_u32 v71, s72, v71
    v_lshrrev_b32 v3, 3, v1
    v_bfe_u32 v4, v1, 4, 1
    v_lshlrev_b32 v4, 2, v4
    v_xor_b32 v4, v4, v1
    v_and_b32 v4, 7, v4
    v_lshlrev_b32 v4, 4, v4
    v_mul_u32_u24 v3, 3584, v3
    v_add_u32 v5, v3, v4
    s_xor_b32 s72, s74, 0
    s_mul_i32 s72, s72, 28672
    s_add_u32 s72, s72, 4096
    v_add_u32 v2, s72, v5
    s_xor_b32 s72, s74, 1
    s_mul_i32 s72, s72, 28672
    s_add_u32 s72, s72, 3072
    v_add_u32 v3, s72, v5
    s_xor_b32 s72, s74, 2
    s_mul_i32 s72, s72, 28672
    s_add_u32 s72, s72, 2048
    v_add_u32 v4, s72, v5
    s_xor_b32 s72, s74, 3
    s_mul_i32 s72, s72, 28672
    s_add_u32 s72, s72, 1024
    v_add_u32 v5, s72, v5
    s_mov_b32 s20, s58
    s_mov_b32 s21, s59
    s_mov_b32 s22, 0x1600000
    s_mov_b32 s23, 0x00020000
    s_mov_b32 s28, s56
    s_mov_b32 s29, s57
    s_mov_b32 s30, 0x100
    s_mov_b32 s31, 0x00020000
    s_mul_i32 s94, s33, 12
    s_add_u32 s94, s94, s34
    s_cmp_lt_u32 s94, 112
    s_cselect_b32 s24, s48, s40
    s_cselect_b32 s25, s49, s41
    s_cselect_b32 s26, 1835008, 0
    s_cselect_b32 s95, 0, 112
    s_max_u32 s26, s26, 524288
    s_mov_b32 s27, 0x00020000
    s_sub_u32 s95, s94, s95
    s_lshl_b32 s95, s95, 14
    s_lshl_b32 s72, s32, 7
    s_add_u32 s43, s95, s72
    s_add_u32 s44, s43, 8192
    s_lshl_b32 s95, s94, 14
    s_lshl_b32 s72, s32, 11
    s_add_u32 s95, s95, s72
    s_add_u32 s95, s95, 0xd00000
    s_cmp_lt_u32 s94, 144
    s_cselect_b32 s45, s95, 0x40000000
    v_and_b32 v40, 31, v1
    v_lshrrev_b32 v41, 5, v1
    v_bfe_u32 v42, v1, 1, 3
    v_xor_b32 v42, v42, v41
    v_xor_b32 v42, s74, v42
    v_lshlrev_b32 v42, 4, v42
    v_lshl_add_u32 v42, v40, 7, v42
    s_lshl_b32 s72, s3, 15
    s_sub_u32 s72, s71, s72
    s_add_u32 s72, s72, 16384
    v_add_u32 v24, s71, v42
    v_add_u32 v100, s72, v42
    v_xor_b32 v25, 32, v24
    v_xor_b32 v26, 64, v24
    v_xor_b32 v27, 96, v24
    v_xor_b32 v101, 32, v100
    v_xor_b32 v102, 64, v100
    v_xor_b32 v103, 96, v100
    v_lshlrev_b32 v29, 12, v41
    v_lshl_add_u32 v29, v40, 2, v29
    v_lshlrev_b32 v10, 4, v1
    s_lshl_b32 s72, s3, 10
    s_add_u32 s72, s72, 32768
    v_lshl_add_u32 v28, v40, 4, s72
    s_lshl_b32 s72, s35, 2
    v_add_u32 v126, s72, v28
    s_mul_i32 s72, s35, 40960
    s_add_u32 s72, s72, 36864
    s_lshl_b32 s73, s3, 9
    s_add_u32 s72, s72, s73
    v_lshl_add_u32 v104, v1, 3, s72
    v_xor_b32 v105, 512, v104
    v_bfe_u32 v40, v1, 2, 2
    v_lshl_add_u32 v42, v41, 3, v40
    v_lshlrev_b32 v42, 7, v42
    v_lshrrev_b32 v40, 1, v40
    v_xor_b32 v40, s3, v40
    v_lshl_add_u32 v42, v40, 6, v42
    v_bfe_u32 v40, v1, 4, 1
    v_lshl_add_u32 v42, v40, 5, v42
    v_and_b32 v43, 7, v1
    v_lshlrev_b32 v40, 2, v40
    v_cmp_eq_u32 vcc, v40, v43
    v_and_b32 v40, 3, v1
    v_lshl_add_u32 v42, v40, 3, v42
    s_mov_b32 s76, 0x3f803f80
    v_mov_b32 v43, s76
    v_cndmask_b32 v118, 0, v43, vcc
    s_xor_b32 s72, s99, 0
    s_mul_i32 s72, s72, 40960
    v_add_u32 v6, s72, v42
    v_mov_b32 v16, 0
    v_cndmask_b32 v119, 0, v43, vcc
    s_xor_b32 s72, s99, 1
    s_mul_i32 s72, s72, 40960
    v_add_u32 v7, s72, v42
    v_mov_b32 v17, 0
    v_cndmask_b32 v120, 0, v43, vcc
    s_xor_b32 s72, s99, 2
    s_mul_i32 s72, s72, 40960
    v_add_u32 v8, s72, v42
    v_mov_b32 v18, 0
    v_cndmask_b32 v121, 0, v43, vcc
    s_xor_b32 s72, s99, 3
    s_mul_i32 s72, s72, 40960
    v_add_u32 v9, s72, v42
    v_mov_b32 v19, 0
    buffer_load_dwordx4 v107, s[4:7], s78 offen offset:1024 lds
    buffer_load_dwordx4 v108, s[4:7], s78 offen offset:2048 lds
    buffer_load_dwordx4 v109, s[4:7], s78 offen offset:3072 lds
    s_add_u32 m0, s70, 8192
    s_nop 0
    buffer_load_dwordx4 v68, s[16:19], s60 offen offset:0 lds
    buffer_load_dwordx4 v69, s[16:19], s60 offen offset:1024 lds
    buffer_load_dwordx4 v70, s[16:19], s60 offen offset:2048 lds
    buffer_load_dwordx4 v71, s[16:19], s60 offen offset:3072 lds
    s_waitcnt vmcnt(8)
    ds_read_b128 v[128:131], v24 offset:0
    ds_read_b128 v[132:135], v25 offset:0
    ds_read_b128 v[136:139], v26 offset:0
    ds_read_b128 v[140:143], v27 offset:0
    s_waitcnt lgkmcnt(0)
    v_dot2_f32_bf16 v16, v128, s76, v16
    v_dot2_f32_bf16 v18, v128, v128, v18
    v_dot2_f32_bf16 v17, v129, s76, v17
    v_dot2_f32_bf16 v19, v129, v129, v19
    v_dot2_f32_bf16 v16, v130, s76, v16
    v_dot2_f32_bf16 v18, v130, v130, v18
    v_dot2_f32_bf16 v17, v131, s76, v17
    v_dot2_f32_bf16 v19, v131, v131, v19
    v_dot2_f32_bf16 v16, v132, s76, v16
    v_dot2_f32_bf16 v18, v132, v132, v18
    v_dot2_f32_bf16 v17, v133, s76, v17
    v_dot2_f32_bf16 v19, v133, v133, v19
    v_dot2_f32_bf16 v16, v134, s76, v16
    v_dot2_f32_bf16 v18, v134, v134, v18
    v_dot2_f32_bf16 v17, v135, s76, v17
    v_dot2_f32_bf16 v19, v135, v135, v19
    v_dot2_f32_bf16 v16, v136, s76, v16
    v_dot2_f32_bf16 v18, v136, v136, v18
    v_dot2_f32_bf16 v17, v137, s76, v17
    v_dot2_f32_bf16 v19, v137, v137, v19
    v_dot2_f32_bf16 v16, v138, s76, v16
    v_dot2_f32_bf16 v18, v138, v138, v18
    v_dot2_f32_bf16 v17, v139, s76, v17
    v_dot2_f32_bf16 v19, v139, v139, v19
    v_dot2_f32_bf16 v16, v140, s76, v16
    v_dot2_f32_bf16 v18, v140, v140, v18
    v_dot2_f32_bf16 v17, v141, s76, v17
    v_dot2_f32_bf16 v19, v141, v141, v19
    v_dot2_f32_bf16 v16, v142, s76, v16
    v_dot2_f32_bf16 v18, v142, v142, v18
    v_dot2_f32_bf16 v17, v143, s76, v17
    v_dot2_f32_bf16 v19, v143, v143, v19
    s_waitcnt vmcnt(4)
    ds_read_b128 v[144:147], v24 offset:4096
    ds_read_b128 v[148:151], v25 offset:4096
    ds_read_b128 v[152:155], v26 offset:4096
    ds_read_b128 v[156:159], v27 offset:4096
    s_waitcnt lgkmcnt(0)
    v_dot2_f32_bf16 v16, v144, s76, v16
    v_dot2_f32_bf16 v18, v144, v144, v18
    v_dot2_f32_bf16 v17, v145, s76, v17
    v_dot2_f32_bf16 v19, v145, v145, v19
    v_dot2_f32_bf16 v16, v146, s76, v16
    v_dot2_f32_bf16 v18, v146, v146, v18
    v_dot2_f32_bf16 v17, v147, s76, v17
    v_dot2_f32_bf16 v19, v147, v147, v19
    v_dot2_f32_bf16 v16, v148, s76, v16
    v_dot2_f32_bf16 v18, v148, v148, v18
    v_dot2_f32_bf16 v17, v149, s76, v17
    v_dot2_f32_bf16 v19, v149, v149, v19
    v_dot2_f32_bf16 v16, v150, s76, v16
    v_dot2_f32_bf16 v18, v150, v150, v18
    v_dot2_f32_bf16 v17, v151, s76, v17
    v_dot2_f32_bf16 v19, v151, v151, v19
    v_dot2_f32_bf16 v16, v152, s76, v16
    v_dot2_f32_bf16 v18, v152, v152, v18
    v_dot2_f32_bf16 v17, v153, s76, v17
    v_dot2_f32_bf16 v19, v153, v153, v19
    v_dot2_f32_bf16 v16, v154, s76, v16
    v_dot2_f32_bf16 v18, v154, v154, v18
    v_dot2_f32_bf16 v17, v155, s76, v17
    v_dot2_f32_bf16 v19, v155, v155, v19
    v_dot2_f32_bf16 v16, v156, s76, v16
    v_dot2_f32_bf16 v18, v156, v156, v18
    v_dot2_f32_bf16 v17, v157, s76, v17
    v_dot2_f32_bf16 v19, v157, v157, v19
    v_dot2_f32_bf16 v16, v158, s76, v16
    v_dot2_f32_bf16 v18, v158, v158, v18
    v_dot2_f32_bf16 v17, v159, s76, v17
    v_dot2_f32_bf16 v19, v159, v159, v19
    s_barrier
    ds_read_b128 v[160:163], v100 offset:0
    ds_read_b128 v[164:167], v101 offset:0
    ds_read_b128 v[168:171], v102 offset:0
    ds_read_b128 v[172:175], v103 offset:0
    ds_read_b128 v[176:179], v100 offset:4096
    ds_read_b128 v[180:183], v101 offset:4096
    ds_read_b128 v[184:187], v102 offset:4096
    ds_read_b128 v[188:191], v103 offset:4096
    s_add_u32 m0, s70, 24576
    s_nop 0
    buffer_load_dwordx4 v2, s[8:11], s61 offen offset:0 lds
    buffer_load_dwordx4 v3, s[8:11], s61 offen offset:1024 lds
    buffer_load_dwordx4 v4, s[8:11], s61 offen offset:2048 lds
    buffer_load_dwordx4 v5, s[8:11], s61 offen offset:3072 lds
    s_cmp_lg_u32 s32, 1
    s_cbranch_scc1 K1a_t1
    s_mov_b64 exec, 0xffffffff
    buffer_load_dword v31, v77, s[16:19], s84 offen
    s_branch K1a_tx
K1a_t1:
    s_cmp_lg_u32 s32, 2
    s_cbranch_scc1 K1a_t2
    s_mov_b64 exec, 0xffffffff
    buffer_load_dword v31, v76, s[8:11], s85 offen
    s_branch K1a_tx
K1a_t2:
    s_cmp_lg_u32 s32, 3
    s_cbranch_scc1 K1a_t3
    s_mov_b64 exec, 0xffffffff
    buffer_load_dword v31, v76, s[12:15], s86 offen
    s_branch K1a_tx
K1a_t3:
K1a_tx:
    s_mov_b64 exec, -1
    s_waitcnt vmcnt(4)
    s_waitcnt lgkmcnt(0)
    s_barrier
    ds_read_b64_tr_b16 v[80:81], v6 offset:8192
    ds_read_b64_tr_b16 v[82:83], v6 offset:8704
    ds_read_b64_tr_b16 v[84:85], v6 offset:10240
    ds_read_b64_tr_b16 v[86:87], v6 offset:10752
    ds_read_b64_tr_b16 v[88:89], v6 offset:12288
    ds_read_b64_tr_b16 v[90:91], v6 offset:12800
    ds_read_b64_tr_b16 v[92:93], v6 offset:14336
    ds_read_b64_tr_b16 v[94:95], v6 offset:14848
    ds_read_b64_tr_b16 v[96:97], v7 offset:8192
    ds_read_b64_tr_b16 v[98:99], v7 offset:8704
    s_waitcnt lgkmcnt(6)
    v_mfma_f32_16x16x32_bf16 v[122:125], v[118:121], v[80:83], 0
    v_mfma_f32_32x32x16_bf16 v[32:47], v[80:83], v[128:131], 0
    s_add_u32 m0, s71, 0
    s_xor_b32 s77, s77, 512
    buffer_load_dwordx4 v106, s[4:7], s77 offen offset:0 lds
    s_lshl_b32 s94, s3, 7
    ds_read_b64_tr_b16 v[80:81], v7 offset:10240
    ds_read_b64_tr_b16 v[82:83], v7 offset:10752
    v_mfma_f32_16x16x32_bf16 v[122:125], v[118:121], v[84:87], v[122:125]
    v_mfma_f32_32x32x16_bf16 v[32:47], v[84:87], v[132:135], v[32:47]
    buffer_load_dwordx4 v107, s[4:7], s77 offen offset:1024 lds
    s_add_u32 s94, s94, s75
    s_lshl_b32 s72, s81, 8
    s_add_u32 s72, s72, s94
    ds_read_b64_tr_b16 v[84:85], v7 offset:12288
    ds_read_b64_tr_b16 v[86:87], v7 offset:12800
    s_waitcnt lgkmcnt(6)
    v_mfma_f32_16x16x32_bf16 v[122:125], v[118:121], v[88:91], v[122:125]
    v_mfma_f32_32x32x16_bf16 v[32:47], v[88:91], v[136:139], v[32:47]
    buffer_load_dwordx4 v108, s[4:7], s77 offen offset:2048 lds
    s_lshl_b32 s36, s72, 10
    s_add_u32 s37, s36, 0x10000
    s_cmp_lt_u32 s81, 8
    s_cselect_b32 s38, 0x3eb8aa3b, 1.0
    ds_read_b64_tr_b16 v[88:89], v7 offset:14336
    ds_read_b64_tr_b16 v[90:91], v7 offset:14848
    v_mfma_f32_16x16x32_bf16 v[122:125], v[118:121], v[92:95], v[122:125]
    v_mfma_f32_32x32x16_bf16 v[32:47], v[92:95], v[140:143], v[32:47]
    buffer_load_dwordx4 v109, s[4:7], s77 offen offset:3072 lds
    s_lshl_b32 s72, s34, 9
    s_add_u32 s72, s72, s94
    s_lshl_b32 s72, s72, 10
    ds_read_b64_tr_b16 v[92:93], v8 offset:8192
    ds_read_b64_tr_b16 v[94:95], v8 offset:8704
    s_waitcnt lgkmcnt(6)
    v_mfma_f32_32x32x16_bf16 v[32:47], v[96:99], v[144:147], v[32:47]
    s_add_u32 s39, s72, 0x400000
    s_add_u32 s40, s39, 262144
    s_mul_i32 s72, s75, 114688
    s_lshl_b32 s73, s34, 13
    s_add_u32 s72, s72, s73
    s_lshl_b32 s73, s3, 11
    s_add_u32 s72, s72, s73
    s_add_u32 s41, s72, 0x600000
    s_add_u32 s42, s72, 0x601000
    ds_read_b64_tr_b16 v[96:97], v8 offset:10240
    ds_read_b64_tr_b16 v[98:99], v8 offset:10752
    v_mfma_f32_32x32x16_bf16 v[32:47], v[80:83], v[148:151], v[32:47]
    s_add_u32 m0, s71, 4096
    s_xor_b32 s78, s78, 512
    buffer_load_dwordx4 v106, s[4:7], s78 offen offset:0 lds
    s_lshl_b32 s94, s3, 6
    ds_read_b64_tr_b16 v[80:81], v8 offset:12288
    ds_read_b64_tr_b16 v[82:83], v8 offset:12800
    s_waitcnt lgkmcnt(6)
    v_mfma_f32_32x32x16_bf16 v[32:47], v[84:87], v[152:155], v[32:47]
    buffer_load_dwordx4 v107, s[4:7], s78 offen offset:1024 lds
    s_add_u32 s94, s94, s75
    s_lshl_b32 s94, s94, 2
    s_add_u32 s94, s94, 0x1200000
    ds_read_b64_tr_b16 v[84:85], v8 offset:14336
    ds_read_b64_tr_b16 v[86:87], v8 offset:14848
    v_mfma_f32_32x32x16_bf16 v[32:47], v[88:91], v[156:159], v[32:47]
    buffer_load_dwordx4 v108, s[4:7], s78 offen offset:2048 lds
    s_lshl_b32 s72, s81, 9
    s_add_u32 s46, s94, s72
    s_lshl_b32 s72, s34, 10
    ds_read_b64_tr_b16 v[88:89], v9 offset:8192
    ds_read_b64_tr_b16 v[90:91], v9 offset:8704
    s_waitcnt lgkmcnt(6)
    v_mfma_f32_32x32x16_bf16 v[32:47], v[92:95], v[160:163], v[32:47]
    buffer_load_dwordx4 v109, s[4:7], s78 offen offset:3072 lds
    s_add_u32 s47, s94, s72
    s_add_u32 s47, s47, 8192
    s_lshl_b32 s72, s75, 4
    ds_read_b64_tr_b16 v[92:93], v9 offset:10240
    ds_read_b64_tr_b16 v[94:95], v9 offset:10752
    v_mfma_f32_32x32x16_bf16 v[32:47], v[96:99], v[164:167], v[32:47]
    s_add_u32 s72, s72, s34
    s_lshl_b32 s72, s72, 1
    s_add_u32 s72, s72, s3
    s_lshl_b32 s72, s72, 2
    s_add_u32 s48, s72, 0x1204000
    s_lshl_b32 s72, s2, 2
    s_add_u32 s72, s72, 0x1208000
    s_cmp_eq_u32 s32, 0
    s_cselect_b32 s49, s72, 0x40000000
    s_and_b32 s82, s2, 7
    ds_read_b64_tr_b16 v[96:97], v9 offset:12288
    ds_read_b64_tr_b16 v[98:99], v9 offset:12800
    s_waitcnt lgkmcnt(6)
    v_mfma_f32_32x32x16_bf16 v[32:47], v[80:83], v[168:171], v[32:47]
    s_add_u32 m0, s70, 0
    s_nop 0
    buffer_load_dwordx4 v68, s[16:19], s62 offen offset:0 lds
    s_lshl_b32 s82, s82, 2
    s_waitcnt vmcnt(9)
    s_barrier
    ds_read_b64_tr_b16 v[80:81], v9 offset:14336
    ds_read_b64_tr_b16 v[82:83], v9 offset:14848
    v_mfma_f32_32x32x16_bf16 v[32:47], v[84:87], v[172:175], v[32:47]
    buffer_load_dwordx4 v69, s[16:19], s62 offen offset:1024 lds
    s_lshr_b32 s72, s2, 6
    s_add_u32 s82, s82, s72
    s_bfe_u32 s83, s2, 0x30003
    ds_read_b64_tr_b16 v[84:85], v6 offset:24576
    ds_read_b64_tr_b16 v[86:87], v6 offset:25088
    s_waitcnt lgkmcnt(6)
    v_mfma_f32_32x32x16_bf16 v[32:47], v[88:91], v[176:179], v[32:47]
    buffer_load_dwordx4 v70, s[16:19], s62 offen offset:2048 lds
    s_lshl_b32 s83, s83, 3
    s_lshl_b32 s72, s35, 1
    s_add_u32 s83, s83, s72
    ds_read_b64_tr_b16 v[88:89], v6 offset:26624
    ds_read_b64_tr_b16 v[90:91], v6 offset:27136
    v_mfma_f32_32x32x16_bf16 v[32:47], v[92:95], v[180:183], v[32:47]
    buffer_load_dwordx4 v71, s[16:19], s62 offen offset:3072 lds
    s_add_u32 s72, s83, s3
    s_lshl_b32 s72, s72, 5
    s_add_u32 s72, s72, s82
    ds_read_b64_tr_b16 v[92:93], v6 offset:28672
    ds_read_b64_tr_b16 v[94:95], v6 offset:29184
    s_waitcnt lgkmcnt(6)
    v_mfma_f32_32x32x16_bf16 v[32:47], v[96:99], v[184:187], v[32:47]
    s_lshl_b32 s72, s72, 10
    s_add_u32 s56, s72, 0x1000000
    s_lshl_b32 s54, s82, 16
    s_lshl_b32 s72, s3, 12
    s_add_u32 s54, s54, s72
    s_lshr_b32 s72, s35, 1
    s_lshl_b32 s72, s72, 15
    s_add_u32 s54, s54, s72
    s_and_b32 s72, s35, 1
    ds_read_b64_tr_b16 v[96:97], v6 offset:30720
    ds_read_b64_tr_b16 v[98:99], v6 offset:31232
    v_mfma_f32_32x32x16_bf16 v[32:47], v[80:83], v[188:191], v[32:47]
    s_lshl_b32 s72, s72, 21
    s_add_u32 s54, s54, s72
    s_add_u32 s54, s54, 0x200000
    s_lshl_b32 s55, s82, 6
    s_add_u32 s55, s55, s83
    s_lshl_b32 s55, s55, 10
    s_lshr_b32 s72, s82, 1
    s_lshl_b32 s72, s72, 8
    s_add_u32 s72, s72, 0x1200000
    s_lshl_b32 s58, s83, 2
    ds_read_b64_tr_b16 v[80:81], v7 offset:24576
    ds_read_b64_tr_b16 v[82:83], v7 offset:25088
    s_waitcnt lgkmcnt(6)
    v_mfma_f32_16x16x32_bf16 v[64:67], v[118:121], v[84:87], 0
    v_mfma_f32_32x32x16_bf16 v[48:63], v[84:87], v[128:131], 0
    s_add_u32 s58, s58, s72
    s_and_b32 s57, s35, 1
    s_lshl_b32 s57, s57, 12
    s_add_u32 s57, s57, s72
    s_add_u32 s57, s57, 4096
    s_sub_u32 s57, s57, s58
    s_lshl_b32 s72, s3, 2
    s_lshl_b32 s72, 0x0f0f0f0f, s72
    ds_read_b64_tr_b16 v[84:85], v7 offset:26624
    ds_read_b64_tr_b16 v[86:87], v7 offset:27136
    v_mfma_f32_16x16x32_bf16 v[64:67], v[118:121], v[88:91], v[64:67]
    v_mfma_f32_32x32x16_bf16 v[48:63], v[88:91], v[132:135], v[48:63]
    s_waitcnt vmcnt(4)
    ds_read_b128 v[192:195], v24 offset:0
    ds_read_b128 v[196:199], v25 offset:0
    s_cmp_lt_u32 s35, 2
    s_cselect_b32 s52, s72, 0
    s_cselect_b32 s53, 0, s72
    s_getpc_b64 s[98:99]
K1a_pc2:
    s_add_u32 s98, s98, K2_start-K1a_pc2
    s_addc_u32 s99, s99, 0
    ds_read_b64_tr_b16 v[88:89], v7 offset:28672
    ds_read_b64_tr_b16 v[90:91], v7 offset:29184
    s_waitcnt lgkmcnt(8)
    v_mfma_f32_16x16x32_bf16 v[64:67], v[118:121], v[92:95], v[64:67]
    v_mfma_f32_32x32x16_bf16 v[48:63], v[92:95], v[136:139], v[48:63]
    ds_read_b128 v[200:203], v26 offset:0
    ds_read_b128 v[204:207], v27 offset:0
    ds_read_b128 v[208:211], v24 offset:4096
    v_lshlrev_b32 v30, 7, v0
    v_min_u32 v30, K2_fallback-K2_start, v30
    s_mov_b32 s94, 0x05040100
    s_mov_b32 s95, 0x07060302
    ds_read_b64_tr_b16 v[92:93], v7 offset:30720
    ds_read_b64_tr_b16 v[94:95], v7 offset:31232
    v_mfma_f32_16x16x32_bf16 v[64:67], v[118:121], v[96:99], v[64:67]
    v_mfma_f32_32x32x16_bf16 v[48:63], v[96:99], v[140:143], v[48:63]
    ds_read_b128 v[212:215], v25 offset:4096
    ds_read_b128 v[216:219], v26 offset:4096
    ds_read_b128 v[220:223], v27 offset:4096
    v_mov_b32 v112, -1
    v_mov_b32 v113, -1
    v_mov_b32 v114, -1
    v_mov_b32 v115, -1
    buffer_store_dwordx4 v[112:115], v10, s[20:23], s56 offen sc1
    s_barrier
    ds_read_b64_tr_b16 v[96:97], v8 offset:24576
    ds_read_b64_tr_b16 v[98:99], v8 offset:25088
    ds_read_b128 v[224:227], v100 offset:0
    ds_read_b128 v[228:231], v101 offset:0
    ds_read_b128 v[232:235], v102 offset:0
    ds_read_b128 v[236:239], v103 offset:0
    ds_read_b128 v[240:243], v100 offset:4096
    ds_read_b128 v[244:247], v101 offset:4096
    ds_read_b128 v[248:251], v102 offset:4096
    ds_read_b128 v[252:255], v103 offset:4096
    s_waitcnt lgkmcnt(15)
    v_dot2_f32_bf16 v16, v192, s76, v16
    v_dot2_f32_bf16 v18, v192, v192, v18
    s_add_u32 m0, s70, 8192
    s_nop 0
    v_dot2_f32_bf16 v17, v193, s76, v17
    v_dot2_f32_bf16 v19, v193, v193, v19
    v_dot2_f32_bf16 v16, v194, s76, v16
    v_dot2_f32_bf16 v18, v194, v194, v18
    v_dot2_f32_bf16 v17, v195, s76, v17
    v_dot2_f32_bf16 v19, v195, v195, v19
    buffer_load_dwordx4 v2, s[8:11], s63 offen offset:0 lds
    v_dot2_f32_bf16 v16, v196, s76, v16
    v_dot2_f32_bf16 v18, v196, v196, v18
    v_dot2_f32_bf16 v17, v197, s76, v17
    v_dot2_f32_bf16 v19, v197, v197, v19
    v_dot2_f32_bf16 v16, v198, s76, v16
    v_dot2_f32_bf16 v18, v198, v198, v18
    v_dot2_f32_bf16 v17, v199, s76, v17
    v_dot2_f32_bf16 v19, v199, v199, v19
    v_dot2_f32_bf16 v16, v200, s76, v16
    v_dot2_f32_bf16 v18, v200, v200, v18
    v_dot2_f32_bf16 v17, v201, s76, v17
    v_dot2_f32_bf16 v19, v201, v201, v19
    v_dot2_f32_bf16 v16, v202, s76, v16
    v_dot2_f32_bf16 v18, v202, v202, v18
    buffer_load_dwordx4 v3, s[8:11], s63 offen offset:1024 lds
    v_dot2_f32_bf16 v17, v203, s76, v17
    v_dot2_f32_bf16 v19, v203, v203, v19
    v_dot2_f32_bf16 v16, v204, s76, v16
    v_dot2_f32_bf16 v18, v204, v204, v18
    v_dot2_f32_bf16 v17, v205, s76, v17
    v_dot2_f32_bf16 v19, v205, v205, v19
    v_dot2_f32_bf16 v16, v206, s76, v16
    v_dot2_f32_bf16 v18, v206, v206, v18
    v_dot2_f32_bf16 v17, v207, s76, v17
    v_dot2_f32_bf16 v19, v207, v207, v19
    s_waitcnt lgkmcnt(10)
    v_dot2_f32_bf16 v16, v208, s76, v16
    v_dot2_f32_bf16 v18, v208, v208, v18
    buffer_load_dwordx4 v4, s[8:11], s63 offen offset:2048 lds
    v_dot2_f32_bf16 v17, v209, s76, v17
    v_dot2_f32_bf16 v19, v209, v209, v19
    v_dot2_f32_bf16 v16, v210, s76, v16
    v_dot2_f32_bf16 v18, v210, v210, v18
    v_dot2_f32_bf16 v17, v211, s76, v17
    v_dot2_f32_bf16 v19, v211, v211, v19
    v_dot2_f32_bf16 v16, v212, s76, v16
    v_dot2_f32_bf16 v18, v212, v212, v18
    v_dot2_f32_bf16 v17, v213, s76, v17
    v_dot2_f32_bf16 v19, v213, v213, v19
    v_dot2_f32_bf16 v16, v214, s76, v16
    v_dot2_f32_bf16 v18, v214, v214, v18
    v_dot2_f32_bf16 v17, v215, s76, v17
    v_dot2_f32_bf16 v19, v215, v215, v19
    buffer_load_dwordx4 v5, s[8:11], s63 offen offset:3072 lds
    v_dot2_f32_bf16 v16, v216, s76, v16
    v_dot2_f32_bf16 v18, v216, v216, v18
    v_dot2_f32_bf16 v17, v217, s76, v17
    v_dot2_f32_bf16 v19, v217, v217, v19
    v_dot2_f32_bf16 v16, v218, s76, v16
    v_dot2_f32_bf16 v18, v218, v218, v18
    v_dot2_f32_bf16 v17, v219, s76, v17
    v_dot2_f32_bf16 v19, v219, v219, v19
    v_dot2_f32_bf16 v16, v220, s76, v16
    v_dot2_f32_bf16 v18, v220, v220, v18
    v_dot2_f32_bf16 v17, v221, s76, v17
    v_dot2_f32_bf16 v19, v221, v221, v19
    v_dot2_f32_bf16 v16, v222, s76, v16
    v_dot2_f32_bf16 v18, v222, v222, v18
    s_cmp_lg_u32 s32, 2
    s_cbranch_scc1 K1a_u2
    s_mov_b64 exec, 0xffffffff
    buffer_load_dword v31, v76, s[8:11], s79 offen
    s_branch K1a_ux
K1a_u2:
    s_cmp_lg_u32 s32, 3
    s_cbranch_scc1 K1a_u3
    s_mov_b64 exec, 0xffffffff
    buffer_load_dword v31, v76, s[12:15], s80 offen
    s_branch K1a_ux
K1a_u3:
    s_cmp_lg_u32 s32, 0
    s_cbranch_scc1 K1a_u0
    global_load_dword v31, v30, s[98:99]
    s_branch K1a_ux
K1a_u0:
    s_cmp_lg_u32 s32, 1
    s_cbranch_scc1 K1a_u1
    s_mov_b64 exec, 0xffffffff
    global_load_dword v31, v30, s[98:99]
    s_branch K1a_ux
K1a_u1:
K1a_ux:
    s_mov_b64 exec, -1
    v_dot2_f32_bf16 v17, v223, s76, v17
    v_dot2_f32_bf16 v19, v223, v223, v19
    v_mfma_f32_32x32x16_bf16 v[48:63], v[80:83], v[144:147], v[48:63]
    ds_read_b64_tr_b16 v[80:81], v8 offset:26624
    ds_read_b64_tr_b16 v[82:83], v8 offset:27136
    v_mfma_f32_32x32x16_bf16 v[48:63], v[84:87], v[148:151], v[48:63]
    buffer_load_dword v108, v29, s[24:27], s43 offen offset:0
    ds_read_b64_tr_b16 v[84:85], v8 offset:28672
    ds_read_b64_tr_b16 v[86:87], v8 offset:29184
    v_mfma_f32_32x32x16_bf16 v[48:63], v[88:91], v[152:155], v[48:63]
    ds_read_b64_tr_b16 v[88:89], v8 offset:30720
    ds_read_b64_tr_b16 v[90:91], v8 offset:31232
    v_mfma_f32_32x32x16_bf16 v[48:63], v[92:95], v[156:159], v[48:63]
    buffer_load_dword v109, v29, s[24:27], s43 offen offset:1024
    ds_read_b64_tr_b16 v[92:93], v9 offset:24576
    ds_read_b64_tr_b16 v[94:95], v9 offset:25088
    s_waitcnt lgkmcnt(6)
    v_mfma_f32_32x32x16_bf16 v[48:63], v[96:99], v[160:163], v[48:63]
    ds_read_b64_tr_b16 v[96:97], v9 offset:26624
    ds_read_b64_tr_b16 v[98:99], v9 offset:27136
    v_mfma_f32_32x32x16_bf16 v[48:63], v[80:83], v[164:167], v[48:63]
    ds_read_b64_tr_b16 v[80:81], v9 offset:28672
    ds_read_b64_tr_b16 v[82:83], v9 offset:29184
    s_waitcnt lgkmcnt(6)
    v_mfma_f32_32x32x16_bf16 v[48:63], v[84:87], v[168:171], v[48:63]
    buffer_load_dword v110, v29, s[24:27], s43 offen offset:2048
    s_waitcnt vmcnt(8)
    s_barrier
    ds_read_b64_tr_b16 v[84:85], v9 offset:30720
    ds_read_b64_tr_b16 v[86:87], v9 offset:31232
    v_mfma_f32_32x32x16_bf16 v[48:63], v[88:91], v[172:175], v[48:63]
    v_add_f32 v16, v16, v17
    v_add_f32 v18, v18, v19
    ds_read_b64_tr_b16 v[88:89], v6 offset:0
    ds_read_b64_tr_b16 v[90:91], v6 offset:512
    s_waitcnt lgkmcnt(6)
    v_mfma_f32_32x32x16_bf16 v[48:63], v[92:95], v[176:179], v[48:63]
    buffer_load_dword v111, v29, s[24:27], s43 offen offset:3072
    s_add_u32 m0, s70, 16384
    s_nop 0
    buffer_load_dwordx4 v2, s[12:15], s64 offen offset:0 lds
    ds_read_b64_tr_b16 v[92:93], v6 offset:2048
    ds_read_b64_tr_b16 v[94:95], v6 offset:2560
    v_mfma_f32_32x32x16_bf16 v[48:63], v[96:99], v[180:183], v[48:63]
    v_mov_b32 v20, v16
    v_mov_b32 v19, v18
    ds_read_b64_tr_b16 v[96:97], v6 offset:4096
    ds_read_b64_tr_b16 v[98:99], v6 offset:4608
    s_waitcnt lgkmcnt(6)
    v_mfma_f32_32x32x16_bf16 v[48:63], v[80:83], v[184:187], v[48:63]
    v_permlane32_swap_b32 v16, v20
    v_permlane32_swap_b32 v18, v19
    ds_read_b64_tr_b16 v[80:81], v6 offset:6144
    ds_read_b64_tr_b16 v[82:83], v6 offset:6656
    v_mfma_f32_32x32x16_bf16 v[48:63], v[84:87], v[188:191], v[48:63]
    buffer_load_dword v112, v29, s[24:27], s44 offen offset:0
    buffer_load_dwordx4 v3, s[12:15], s64 offen offset:1024 lds
    ds_read_b64_tr_b16 v[84:85], v7 offset:0
    ds_read_b64_tr_b16 v[86:87], v7 offset:512
    s_waitcnt lgkmcnt(6)
    v_mfma_f32_16x16x32_bf16 v[122:125], v[118:121], v[88:91], v[122:125]
    v_mfma_f32_32x32x16_bf16 v[32:47], v[88:91], v[192:195], v[32:47]
    v_add_f32 v16, v16, v20
    v_add_f32 v17, v18, v19
    ds_write_b64 v104, v[16:17]
    ds_read_b64_tr_b16 v[88:89], v7 offset:2048
    ds_read_b64_tr_b16 v[90:91], v7 offset:2560
    v_mfma_f32_16x16x32_bf16 v[122:125], v[118:121], v[92:95], v[122:125]
    v_mfma_f32_32x32x16_bf16 v[32:47], v[92:95], v[196:199], v[32:47]
    v_mov_b32 v26, 0
    v_mov_b32 v27, 0
    ds_read_b64_tr_b16 v[92:93], v7 offset:4096
    ds_read_b64_tr_b16 v[94:95], v7 offset:4608
    s_waitcnt lgkmcnt(7)
    v_mfma_f32_16x16x32_bf16 v[122:125], v[118:121], v[96:99], v[122:125]
    v_mfma_f32_32x32x16_bf16 v[32:47], v[96:99], v[200:203], v[32:47]
    buffer_load_dword v113, v29, s[24:27], s44 offen offset:1024
    ds_read_b64_tr_b16 v[96:97], v7 offset:6144
    ds_read_b64_tr_b16 v[98:99], v7 offset:6656
    v_mfma_f32_16x16x32_bf16 v[122:125], v[118:121], v[80:83], v[122:125]
    v_mfma_f32_32x32x16_bf16 v[32:47], v[80:83], v[204:207], v[32:47]
    buffer_load_dwordx4 v4, s[12:15], s64 offen offset:2048 lds
    ds_read_b64_tr_b16 v[80:81], v8 offset:0
    ds_read_b64_tr_b16 v[82:83], v8 offset:512
    s_waitcnt lgkmcnt(6)
    v_mfma_f32_32x32x16_bf16 v[32:47], v[84:87], v[208:211], v[32:47]
    buffer_load_dword v114, v29, s[24:27], s44 offen offset:2048
    ds_read_b64_tr_b16 v[84:85], v8 offset:2048
    ds_read_b64_tr_b16 v[86:87], v8 offset:2560
    v_mfma_f32_32x32x16_bf16 v[32:47], v[88:91], v[212:215], v[32:47]
    ds_read_b64_tr_b16 v[88:89], v8 offset:4096
    ds_read_b64_tr_b16 v[90:91], v8 offset:4608
    s_waitcnt lgkmcnt(6)
    v_mfma_f32_32x32x16_bf16 v[32:47], v[92:95], v[216:219], v[32:47]
    buffer_load_dwordx4 v5, s[12:15], s64 offen offset:3072 lds
    ds_read_b64_tr_b16 v[92:93], v8 offset:6144
    ds_read_b64_tr_b16 v[94:95], v8 offset:6656
    v_mfma_f32_32x32x16_bf16 v[32:47], v[96:99], v[220:223], v[32:47]
    buffer_load_dword v115, v29, s[24:27], s44 offen offset:3072
    ds_write_b32 v126, v122 offset:0
    ds_read_b64_tr_b16 v[96:97], v9 offset:0
    ds_read_b64_tr_b16 v[98:99], v9 offset:512
    s_waitcnt lgkmcnt(7)
    v_mfma_f32_32x32x16_bf16 v[32:47], v[80:83], v[224:227], v[32:47]
    ds_read_b64_tr_b16 v[80:81], v9 offset:2048
    ds_read_b64_tr_b16 v[82:83], v9 offset:2560
    v_mfma_f32_32x32x16_bf16 v[32:47], v[84:87], v[228:231], v[32:47]
    ds_read_b64_tr_b16 v[84:85], v9 offset:4096
    ds_read_b64_tr_b16 v[86:87], v9 offset:4608
    s_waitcnt lgkmcnt(7)
    v_mfma_f32_32x32x16_bf16 v[32:47], v[88:91], v[232:235], v[32:47]
    s_waitcnt vmcnt(12)
    s_waitcnt lgkmcnt(6)
    s_barrier
    ds_read_b64_tr_b16 v[88:89], v9 offset:6144
    ds_read_b64_tr_b16 v[90:91], v9 offset:6656
    v_mfma_f32_32x32x16_bf16 v[32:47], v[92:95], v[236:239], v[32:47]
    ds_read_b64 v[18:19], v105
    ds_read_b128 v[122:125], v28 offset:0
    ds_read_b64_tr_b16 v[92:93], v6 offset:8192
    ds_read_b64_tr_b16 v[94:95], v6 offset:8704
    s_waitcnt lgkmcnt(8)
    v_mfma_f32_32x32x16_bf16 v[32:47], v[96:99], v[240:243], v[32:47]
    s_add_u32 m0, s70, 24576
    s_nop 0
    buffer_load_dwordx4 v2, s[12:15], s65 offen offset:0 lds
    ds_read_b64_tr_b16 v[96:97], v6 offset:10240
    ds_read_b64_tr_b16 v[98:99], v6 offset:10752
    v_mfma_f32_32x32x16_bf16 v[32:47], v[80:83], v[244:247], v[32:47]
    s_waitcnt lgkmcnt(4)
    v_add_f32 v122, v122, v123
    v_add_f32 v124, v124, v125
    v_add_f32 v122, v122, v124
    v_cmp_gt_u32 vcc, 32, v1
    ds_read_b64_tr_b16 v[80:81], v6 offset:12288
    ds_read_b64_tr_b16 v[82:83], v6 offset:12800
    v_mfma_f32_32x32x16_bf16 v[32:47], v[84:87], v[248:251], v[32:47]
    v_cvt_pk_bf16_f32 v117, v122, v122
    v_and_b32 v123, 0xffff0000, v117
    v_sub_f32 v123, v122, v123
    v_cvt_pk_bf16_f32 v116, v122, v123
    v_add_f32 v16, v16, v18
    v_mul_f32 v16, 0xbb000000, v16
    ds_read_b64_tr_b16 v[84:85], v6 offset:14336
    ds_read_b64_tr_b16 v[86:87], v6 offset:14848
    v_mfma_f32_32x32x16_bf16 v[32:47], v[88:91], v[252:255], v[32:47]
    buffer_load_dwordx4 v3, s[12:15], s65 offen offset:1024 lds
    v_add_f32 v17, v17, v19
    v_cvt_pk_bf16_f32 v18, v16, v16
    ds_read_b64_tr_b16 v[88:89], v7 offset:8192
    ds_read_b64_tr_b16 v[90:91], v7 offset:8704
    s_waitcnt lgkmcnt(6)
    v_mfma_f32_16x16x32_bf16 v[64:67], v[118:121], v[92:95], v[64:67]
    v_mfma_f32_32x32x16_bf16 v[48:63], v[92:95], v[192:195], v[48:63]
    v_mul_f32 v17, 0x3b000000, v17
    v_and_b32 v19, 0xffff0000, v18
    v_fma_f32 v17, -v16, v16, v17
    v_sub_f32 v19, v16, v19
    v_max_f32 v17, 0, v17
    v_cvt_pk_bf16_f32 v19, v19, 0
    ds_read_b64_tr_b16 v[92:93], v7 offset:10240
    ds_read_b64_tr_b16 v[94:95], v7 offset:10752
    v_mfma_f32_16x16x32_bf16 v[64:67], v[118:121], v[96:99], v[64:67]
    v_mfma_f32_32x32x16_bf16 v[48:63], v[96:99], v[196:199], v[48:63]
    v_add_f32 v14, 0x3727c5ac, v17
    v_cndmask_b32 v24, 0, v18, vcc
    v_rsq_f32 v15, v14
    v_cndmask_b32 v25, 0, v19, vcc
    ds_read_b64_tr_b16 v[96:97], v7 offset:12288
    ds_read_b64_tr_b16 v[98:99], v7 offset:12800
    s_waitcnt lgkmcnt(6)
    v_mfma_f32_16x16x32_bf16 v[64:67], v[118:121], v[80:83], v[64:67]
    v_mfma_f32_32x32x16_bf16 v[48:63], v[80:83], v[200:203], v[48:63]
    v_mfma_f32_32x32x16_bf16 v[32:47], v[116:119], v[24:27], v[32:47]
    v_mul_f32 v12, 0xc0135761, v15
    v_mul_f32 v13, v15, v15
    v_mul_f32 v22, s38, v15
    ds_read_b64_tr_b16 v[80:81], v7 offset:14336
    ds_read_b64_tr_b16 v[82:83], v7 offset:14848
    v_mfma_f32_16x16x32_bf16 v[64:67], v[118:121], v[84:87], v[64:67]
    v_mfma_f32_32x32x16_bf16 v[48:63], v[84:87], v[204:207], v[48:63]
    buffer_load_dwordx4 v4, s[12:15], s65 offen offset:2048 lds
    ds_read_b64_tr_b16 v[84:85], v8 offset:8192
    ds_read_b64_tr_b16 v[86:87], v8 offset:8704
    s_waitcnt lgkmcnt(6)
    v_mfma_f32_32x32x16_bf16 v[48:63], v[88:91], v[208:211], v[48:63]
    v_mul_f32 v13, v13, v12
    v_mul_f32 v13, 0x3d372713, v13
    ds_read_b64_tr_b16 v[88:89], v8 offset:10240
    ds_read_b64_tr_b16 v[90:91], v8 offset:10752
    v_mfma_f32_32x32x16_bf16 v[48:63], v[92:95], v[212:215], v[48:63]
    v_mul_f32 v32, v32, v22
    v_mul_f32 v33, v33, v22
    v_cvt_pk_bf16_f32 v32, v32, v33
    v_mul_f32 v34, v34, v22
    ds_read_b64_tr_b16 v[92:93], v8 offset:12288
    ds_read_b64_tr_b16 v[94:95], v8 offset:12800
    s_waitcnt lgkmcnt(6)
    v_mfma_f32_32x32x16_bf16 v[48:63], v[96:99], v[216:219], v[48:63]
    buffer_load_dwordx4 v5, s[12:15], s65 offen offset:3072 lds
    ds_read_b64_tr_b16 v[96:97], v8 offset:14336
    ds_read_b64_tr_b16 v[98:99], v8 offset:14848
    v_mfma_f32_32x32x16_bf16 v[48:63], v[80:83], v[220:223], v[48:63]
    ds_write_b32 v126, v64 offset:512
    v_mul_f32 v35, v35, v22
    v_cvt_pk_bf16_f32 v33, v34, v35
    v_mul_f32 v36, v36, v22
    v_mul_f32 v37, v37, v22
    ds_read_b64_tr_b16 v[80:81], v9 offset:8192
    ds_read_b64_tr_b16 v[82:83], v9 offset:8704
    s_waitcnt lgkmcnt(7)
    v_mfma_f32_32x32x16_bf16 v[48:63], v[84:87], v[224:227], v[48:63]
    v_cvt_pk_bf16_f32 v34, v36, v37
    v_mul_f32 v38, v38, v22
    v_mul_f32 v39, v39, v22
    ds_read_b64_tr_b16 v[84:85], v9 offset:10240
    ds_read_b64_tr_b16 v[86:87], v9 offset:10752
    v_mfma_f32_32x32x16_bf16 v[48:63], v[88:91], v[228:231], v[48:63]
    v_cvt_pk_bf16_f32 v35, v38, v39
    buffer_store_dwordx4 v[32:35], v10, s[20:23], s36 offen sc1
    ds_read_b64_tr_b16 v[88:89], v9 offset:12288
    ds_read_b64_tr_b16 v[90:91], v9 offset:12800
    s_waitcnt lgkmcnt(7)
    v_mfma_f32_32x32x16_bf16 v[48:63], v[92:95], v[232:235], v[48:63]
    v_mul_f32 v40, v40, v22
    v_mul_f32 v41, v41, v22
    v_cvt_pk_bf16_f32 v40, v40, v41
    v_mul_f32 v42, v42, v22
    s_waitcnt vmcnt(6)
    s_waitcnt lgkmcnt(6)
    s_barrier
    ds_read_b64_tr_b16 v[92:93], v9 offset:14336
    ds_read_b64_tr_b16 v[94:95], v9 offset:14848
    v_mfma_f32_32x32x16_bf16 v[48:63], v[96:99], v[236:239], v[48:63]
    ds_read_b128 v[16:19], v28 offset:512
    v_mul_f32 v43, v43, v22
    v_cvt_pk_bf16_f32 v41, v42, v43
    v_mul_f32 v44, v44, v22
    ds_read_b64_tr_b16 v[96:97], v6 offset:16384
    ds_read_b64_tr_b16 v[98:99], v6 offset:16896
    s_waitcnt lgkmcnt(7)
    v_mfma_f32_32x32x16_bf16 v[48:63], v[80:83], v[240:243], v[48:63]
    s_add_u32 m0, s70, 0
    s_nop 0
    buffer_load_dwordx4 v2, s[8:11], s66 offen offset:0 lds
    ds_read_b64_tr_b16 v[80:81], v6 offset:18432
    ds_read_b64_tr_b16 v[82:83], v6 offset:18944
    v_mfma_f32_32x32x16_bf16 v[48:63], v[84:87], v[244:247], v[48:63]
    s_waitcnt lgkmcnt(4)
    v_add_f32 v16, v16, v17
    v_add_f32 v18, v18, v19
    v_add_f32 v16, v16, v18
    ds_read_b64_tr_b16 v[84:85], v6 offset:20480
    ds_read_b64_tr_b16 v[86:87], v6 offset:20992
    v_mfma_f32_32x32x16_bf16 v[48:63], v[88:91], v[248:251], v[48:63]
    v_cvt_pk_bf16_f32 v117, v16, v16
    v_and_b32 v17, 0xffff0000, v117
    v_sub_f32 v17, v16, v17
    v_cvt_pk_bf16_f32 v116, v16, v17
    ds_read_b64_tr_b16 v[88:89], v6 offset:22528
    ds_read_b64_tr_b16 v[90:91], v6 offset:23040
    v_mfma_f32_32x32x16_bf16 v[48:63], v[92:95], v[252:255], v[48:63]
    buffer_load_dwordx4 v3, s[8:11], s66 offen offset:1024 lds
    v_mfma_f32_32x32x16_bf16 v[48:63], v[116:119], v[24:27], v[48:63]
    v_mul_f32 v45, v45, v22
    ds_read_b64_tr_b16 v[92:93], v7 offset:16384
    ds_read_b64_tr_b16 v[94:95], v7 offset:16896
    s_waitcnt lgkmcnt(6)
    v_mfma_f32_16x16x32_bf16 v[122:125], v[118:121], v[96:99], 0
    v_mfma_f32_32x32x16_bf16 v[64:79], v[96:99], v[128:131], 0
    v_cvt_pk_bf16_f32 v42, v44, v45
    v_mul_f32 v46, v46, v22
    v_mul_f32 v47, v47, v22
    ds_read_b64_tr_b16 v[96:97], v7 offset:18432
    ds_read_b64_tr_b16 v[98:99], v7 offset:18944
    v_mfma_f32_16x16x32_bf16 v[122:125], v[118:121], v[80:83], v[122:125]
    v_mfma_f32_32x32x16_bf16 v[64:79], v[80:83], v[132:135], v[64:79]
    v_cvt_pk_bf16_f32 v43, v46, v47
    buffer_store_dwordx4 v[40:43], v10, s[20:23], s37 offen sc1
    ds_read_b64_tr_b16 v[80:81], v7 offset:20480
    ds_read_b64_tr_b16 v[82:83], v7 offset:20992
    s_waitcnt lgkmcnt(6)
    v_mfma_f32_16x16x32_bf16 v[122:125], v[118:121], v[84:87], v[122:125]
    v_mfma_f32_32x32x16_bf16 v[64:79], v[84:87], v[136:139], v[64:79]
    s_waitcnt vmcnt(8)
    v_perm_b32 v100, v109, v108, s94
    v_perm_b32 v101, v111, v110, s94
    v_mul_f32 v20, v48, v48
    v_mul_f32 v21, v49, v49
    ds_read_b64_tr_b16 v[84:85], v7 offset:22528
    ds_read_b64_tr_b16 v[86:87], v7 offset:23040
    v_mfma_f32_16x16x32_bf16 v[122:125], v[118:121], v[88:91], v[122:125]
    v_mfma_f32_32x32x16_bf16 v[64:79], v[88:91], v[140:143], v[64:79]
    buffer_load_dwordx4 v4, s[8:11], s66 offen offset:2048 lds
    v_fma_f32 v20, v20, v13, v12
    ds_read_b64_tr_b16 v[88:89], v8 offset:16384
    ds_read_b64_tr_b16 v[90:91], v8 offset:16896
    s_waitcnt lgkmcnt(6)
    v_mfma_f32_32x32x16_bf16 v[64:79], v[92:95], v[144:147], v[64:79]
    v_perm_b32 v102, v113, v112, s94
    v_perm_b32 v103, v115, v114, s94
    v_fma_f32 v21, v21, v13, v12
    v_mul_f32 v20, v20, v48
    v_mul_f32 v21, v21, v49
    ds_read_b64_tr_b16 v[92:93], v8 offset:18432
    ds_read_b64_tr_b16 v[94:95], v8 offset:18944
    v_mfma_f32_32x32x16_bf16 v[64:79], v[96:99], v[148:151], v[64:79]
    buffer_store_dwordx4 v[100:103], v10, s[20:23], s45 offen sc1
    ds_read_b64_tr_b16 v[96:97], v8 offset:20480
    ds_read_b64_tr_b16 v[98:99], v8 offset:20992
    s_waitcnt lgkmcnt(6)
    v_mfma_f32_32x32x16_bf16 v[64:79], v[80:83], v[152:155], v[64:79]
    buffer_load_dwordx4 v5, s[8:11], s66 offen offset:3072 lds
    v_exp_f32 v20, v20
    ds_read_b64_tr_b16 v[80:81], v8 offset:22528
    ds_read_b64_tr_b16 v[82:83], v8 offset:23040
    v_mfma_f32_32x32x16_bf16 v[64:79], v[84:87], v[156:159], v[64:79]
    v_perm_b32 v104, v109, v108, s95
    v_exp_f32 v21, v21
    v_fma_f32 v20, v20, v14, v14
    v_fma_f32 v21, v21, v14, v14
    ds_read_b64_tr_b16 v[84:85], v9 offset:16384
    ds_read_b64_tr_b16 v[86:87], v9 offset:16896
    s_waitcnt lgkmcnt(6)
    v_mfma_f32_32x32x16_bf16 v[64:79], v[88:91], v[160:163], v[64:79]
    v_perm_b32 v105, v111, v110, s95
    v_perm_b32 v106, v113, v112, s95
    v_rcp_f32 v20, v20
    ds_read_b64_tr_b16 v[88:89], v9 offset:18432
    ds_read_b64_tr_b16 v[90:91], v9 offset:18944
    v_mfma_f32_32x32x16_bf16 v[64:79], v[92:95], v[164:167], v[64:79]
    v_perm_b32 v107, v115, v114, s95
    v_rcp_f32 v21, v21
    v_mul_f32 v48, v48, v20
    ds_read_b64_tr_b16 v[92:93], v9 offset:20480
    ds_read_b64_tr_b16 v[94:95], v9 offset:20992
    s_waitcnt lgkmcnt(6)
    v_mfma_f32_32x32x16_bf16 v[64:79], v[96:99], v[168:171], v[64:79]
    buffer_load_dword v31, v26, s[28:31], 0 offen
    v_mul_f32 v49, v49, v21
    v_mul_f32 v20, v50, v50
    s_waitcnt vmcnt(8)
    s_barrier
    ds_read_b64_tr_b16 v[96:97], v9 offset:22528
    ds_read_b64_tr_b16 v[98:99], v9 offset:23040
    v_mfma_f32_32x32x16_bf16 v[64:79], v[80:83], v[172:175], v[64:79]
    buffer_store_dwordx4 v[104:107], v10, s[20:23], s45 offen offset:1024 sc1
    v_mul_f32 v21, v51, v51
    ds_read_b64_tr_b16 v[80:81], v6 offset:24576
    ds_read_b64_tr_b16 v[82:83], v6 offset:25088
    s_waitcnt lgkmcnt(6)
    v_mfma_f32_32x32x16_bf16 v[64:79], v[84:87], v[176:179], v[64:79]
    s_add_u32 m0, s70, 8192
    s_nop 0
    buffer_load_dwordx4 v2, s[8:11], s67 offen offset:0 lds
    ds_read_b64_tr_b16 v[84:85], v6 offset:26624
    ds_read_b64_tr_b16 v[86:87], v6 offset:27136
    v_mfma_f32_32x32x16_bf16 v[64:79], v[88:91], v[180:183], v[64:79]
    buffer_load_dwordx4 v3, s[8:11], s67 offen offset:1024 lds
    v_fma_f32 v20, v20, v13, v12
    v_fma_f32 v21, v21, v13, v12
    ds_read_b64_tr_b16 v[88:89], v6 offset:28672
    ds_read_b64_tr_b16 v[90:91], v6 offset:29184
    s_waitcnt lgkmcnt(6)
    v_mfma_f32_32x32x16_bf16 v[64:79], v[92:95], v[184:187], v[64:79]
    buffer_load_dwordx4 v4, s[8:11], s67 offen offset:2048 lds
    v_mul_f32 v20, v20, v50
    ds_read_b64_tr_b16 v[92:93], v6 offset:30720
    ds_read_b64_tr_b16 v[94:95], v6 offset:31232
    v_mfma_f32_32x32x16_bf16 v[64:79], v[96:99], v[188:191], v[64:79]
    buffer_load_dwordx4 v5, s[8:11], s67 offen offset:3072 lds
    v_mul_f32 v21, v21, v51
    ds_read_b64_tr_b16 v[96:97], v7 offset:24576
    ds_read_b64_tr_b16 v[98:99], v7 offset:25088
    s_waitcnt lgkmcnt(6)
    v_mfma_f32_16x16x32_bf16 v[122:125], v[118:121], v[80:83], v[122:125]
    v_mfma_f32_32x32x16_bf16 v[64:79], v[80:83], v[192:195], v[64:79]
    v_exp_f32 v20, v20
    v_exp_f32 v21, v21
    v_fma_f32 v20, v20, v14, v14
    ds_read_b64_tr_b16 v[80:81], v7 offset:26624
    ds_read_b64_tr_b16 v[82:83], v7 offset:27136
    v_mfma_f32_16x16x32_bf16 v[122:125], v[118:121], v[84:87], v[122:125]
    v_mfma_f32_32x32x16_bf16 v[64:79], v[84:87], v[196:199], v[64:79]
    v_fma_f32 v21, v21, v14, v14
    v_rcp_f32 v20, v20
    v_rcp_f32 v21, v21
    ds_read_b64_tr_b16 v[84:85], v7 offset:28672
    ds_read_b64_tr_b16 v[86:87], v7 offset:29184
    s_waitcnt lgkmcnt(6)
    v_mfma_f32_16x16x32_bf16 v[122:125], v[118:121], v[88:91], v[122:125]
    v_mfma_f32_32x32x16_bf16 v[64:79], v[88:91], v[200:203], v[64:79]
    v_mul_f32 v50, v50, v20
    v_mul_f32 v51, v51, v21
    v_mul_f32 v20, v52, v52
    v_mul_f32 v21, v53, v53
    ds_read_b64_tr_b16 v[88:89], v7 offset:30720
    ds_read_b64_tr_b16 v[90:91], v7 offset:31232
    v_mfma_f32_16x16x32_bf16 v[122:125], v[118:121], v[92:95], v[122:125]
    v_mfma_f32_32x32x16_bf16 v[64:79], v[92:95], v[204:207], v[64:79]
    v_fma_f32 v20, v20, v13, v12
    v_fma_f32 v21, v21, v13, v12
    v_mul_f32 v20, v20, v52
    v_mul_f32 v21, v21, v53
    ds_read_b64_tr_b16 v[92:93], v8 offset:24576
    ds_read_b64_tr_b16 v[94:95], v8 offset:25088
    s_waitcnt lgkmcnt(6)
    v_mfma_f32_32x32x16_bf16 v[64:79], v[96:99], v[208:211], v[64:79]
    v_exp_f32 v20, v20
    v_exp_f32 v21, v21
    ds_read_b64_tr_b16 v[96:97], v8 offset:26624
    ds_read_b64_tr_b16 v[98:99], v8 offset:27136
    v_mfma_f32_32x32x16_bf16 v[64:79], v[80:83], v[212:215], v[64:79]
    v_fma_f32 v20, v20, v14, v14
    v_fma_f32 v21, v21, v14, v14
    v_rcp_f32 v20, v20
    ds_read_b64_tr_b16 v[80:81], v8 offset:28672
    ds_read_b64_tr_b16 v[82:83], v8 offset:29184
    s_waitcnt lgkmcnt(6)
    v_mfma_f32_32x32x16_bf16 v[64:79], v[84:87], v[216:219], v[64:79]
    v_rcp_f32 v21, v21
    v_mul_f32 v52, v52, v20
    v_mul_f32 v53, v53, v21
    v_mul_f32 v20, v54, v54
    ds_read_b64_tr_b16 v[84:85], v8 offset:30720
    ds_read_b64_tr_b16 v[86:87], v8 offset:31232
    v_mfma_f32_32x32x16_bf16 v[64:79], v[88:91], v[220:223], v[64:79]
    ds_write_b32 v126, v122 offset:0
    v_mul_f32 v21, v55, v55
    v_fma_f32 v20, v20, v13, v12
    v_fma_f32 v21, v21, v13, v12
    v_mul_f32 v20, v20, v54
    ds_read_b64_tr_b16 v[88:89], v9 offset:24576
    ds_read_b64_tr_b16 v[90:91], v9 offset:25088
    s_waitcnt lgkmcnt(7)
    v_mfma_f32_32x32x16_bf16 v[64:79], v[92:95], v[224:227], v[64:79]
    v_mul_f32 v21, v21, v55
    v_exp_f32 v20, v20
    v_exp_f32 v21, v21
    ds_read_b64_tr_b16 v[92:93], v9 offset:26624
    ds_read_b64_tr_b16 v[94:95], v9 offset:27136
    v_mfma_f32_32x32x16_bf16 v[64:79], v[96:99], v[228:231], v[64:79]
    v_fma_f32 v20, v20, v14, v14
    v_fma_f32 v21, v21, v14, v14
    v_rcp_f32 v20, v20
    ds_read_b64_tr_b16 v[96:97], v9 offset:28672
    ds_read_b64_tr_b16 v[98:99], v9 offset:29184
    s_waitcnt lgkmcnt(7)
    v_mfma_f32_32x32x16_bf16 v[64:79], v[80:83], v[232:235], v[64:79]
    v_rcp_f32 v21, v21
    v_mul_f32 v54, v54, v20
    v_mul_f32 v55, v55, v21
    s_waitcnt vmcnt(6)
    s_waitcnt lgkmcnt(6)
    s_barrier
    ds_read_b64_tr_b16 v[80:81], v9 offset:30720
    ds_read_b64_tr_b16 v[82:83], v9 offset:31232
    v_mfma_f32_32x32x16_bf16 v[64:79], v[84:87], v[236:239], v[64:79]
    ds_read_b128 v[16:19], v28 offset:0
    v_mul_f32 v20, v56, v56
    v_mul_f32 v21, v57, v57
    v_fma_f32 v20, v20, v13, v12
    v_fma_f32 v21, v21, v13, v12
    ds_read_b64_tr_b16 v[84:85], v6 offset:0
    ds_read_b64_tr_b16 v[86:87], v6 offset:512
    s_waitcnt lgkmcnt(7)
    v_mfma_f32_32x32x16_bf16 v[64:79], v[88:91], v[240:243], v[64:79]
    v_lshlrev_b32 v108, 2, v1
    v_mul_f32 v20, v20, v56
    v_mul_f32 v21, v21, v57
    v_exp_f32 v20, v20
    ds_read_b64_tr_b16 v[88:89], v6 offset:2048
    ds_read_b64_tr_b16 v[90:91], v6 offset:2560
    v_mfma_f32_32x32x16_bf16 v[64:79], v[92:95], v[244:247], v[64:79]
    s_waitcnt lgkmcnt(4)
    v_add_f32 v16, v16, v17
    v_add_f32 v18, v18, v19
    v_add_f32 v16, v16, v18
    ds_read_b64_tr_b16 v[92:93], v6 offset:4096
    ds_read_b64_tr_b16 v[94:95], v6 offset:4608
    v_mfma_f32_32x32x16_bf16 v[64:79], v[96:99], v[248:251], v[64:79]
    v_cvt_pk_bf16_f32 v117, v16, v16
    v_and_b32 v17, 0xffff0000, v117
    v_sub_f32 v17, v16, v17
    v_cvt_pk_bf16_f32 v116, v16, v17
    ds_read_b64_tr_b16 v[96:97], v6 offset:6144
    ds_read_b64_tr_b16 v[98:99], v6 offset:6656
    v_mfma_f32_32x32x16_bf16 v[64:79], v[80:83], v[252:255], v[64:79]
    v_mfma_f32_32x32x16_bf16 v[64:79], v[116:119], v[24:27], v[64:79]
    v_and_b32 v110, 4, v108
    v_add_u32 v109, s57, v108
    v_exp_f32 v21, v21
    v_fma_f32 v20, v20, v14, v14
    ds_read_b64_tr_b16 v[80:81], v7 offset:0
    ds_read_b64_tr_b16 v[82:83], v7 offset:512
    s_waitcnt lgkmcnt(6)
    v_mfma_f32_16x16x32_bf16 v[122:125], v[118:121], v[84:87], 0
    v_mfma_f32_32x32x16_bf16 v[32:47], v[84:87], v[128:131], 0
    v_cndmask_b32 v108, v110, v109, s[52:53]
    v_fma_f32 v21, v21, v14, v14
    v_rcp_f32 v20, v20
    ds_read_b64_tr_b16 v[84:85], v7 offset:2048
    ds_read_b64_tr_b16 v[86:87], v7 offset:2560
    v_mfma_f32_16x16x32_bf16 v[122:125], v[118:121], v[88:91], v[122:125]
    v_mfma_f32_32x32x16_bf16 v[32:47], v[88:91], v[132:135], v[32:47]
    v_and_b32 v112, 22, v0
    v_rcp_f32 v21, v21
    v_mul_f32 v56, v56, v20
    ds_read_b64_tr_b16 v[88:89], v7 offset:4096
    ds_read_b64_tr_b16 v[90:91], v7 offset:4608
    s_waitcnt lgkmcnt(6)
    v_mfma_f32_16x16x32_bf16 v[122:125], v[118:121], v[92:95], v[122:125]
    v_mfma_f32_32x32x16_bf16 v[32:47], v[92:95], v[136:139], v[32:47]
    v_mul_f32 v57, v57, v21
    v_mul_f32 v20, v58, v58
    v_mul_f32 v21, v59, v59
    v_fma_f32 v20, v20, v13, v12
    v_fma_f32 v21, v21, v13, v12
    s_waitcnt vmcnt(5)
    v_cmp_eq_u32 vcc, 0, v31
    s_nop 4
    s_cbranch_vccz K1a_nn1
    s_mov_b32 s74, 262144
K1a_nn0:
    buffer_load_dword v31, v26, s[28:31], 0 offen sc1
    s_waitcnt vmcnt(0)
    v_cmp_eq_u32 vcc, 0, v31
    s_nop 4
    s_cbranch_vccz K1a_nn1
    s_sub_u32 s74, s74, 1
    s_cbranch_scc0 K1a_nn0
K1a_nn1:
    v_readfirstlane_b32 s59, v31
    s_waitcnt vmcnt(0)
    s_mov_b64 exec, 1
    buffer_store_dword v31, v10, s[20:23], s46 offen offset:0 sc1
    s_mov_b64 exec, -1
    ds_read_b64_tr_b16 v[92:93], v7 offset:6144
    ds_read_b64_tr_b16 v[94:95], v7 offset:6656
    v_mfma_f32_16x16x32_bf16 v[122:125], v[118:121], v[96:99], v[122:125]
    v_mfma_f32_32x32x16_bf16 v[32:47], v[96:99], v[140:143], v[32:47]
    v_cmp_eq_u32 vcc, 0, v112
    v_mov_b32 v113, s76
    v_lshlrev_b32 v112, 3, v0
    v_cndmask_b32 v114, 0, v113, vcc
    v_cndmask_b32 v115, 0, v113, vcc
    ds_read_b64_tr_b16 v[96:97], v8 offset:0
    ds_read_b64_tr_b16 v[98:99], v8 offset:512
    s_waitcnt lgkmcnt(6)
    v_mfma_f32_32x32x16_bf16 v[32:47], v[80:83], v[144:147], v[32:47]
    s_add_u32 m0, s70, 16384
    s_nop 0
    buffer_load_dwordx4 v2, s[12:15], s68 offen offset:0 lds
    ds_read_b64_tr_b16 v[80:81], v8 offset:2048
    ds_read_b64_tr_b16 v[82:83], v8 offset:2560
    v_mfma_f32_32x32x16_bf16 v[32:47], v[84:87], v[148:151], v[32:47]
    v_mul_f32 v20, v20, v58
    v_mul_f32 v21, v21, v59
    v_exp_f32 v20, v20
    ds_read_b64_tr_b16 v[84:85], v8 offset:4096
    ds_read_b64_tr_b16 v[86:87], v8 offset:4608
    s_waitcnt lgkmcnt(6)
    v_mfma_f32_32x32x16_bf16 v[32:47], v[88:91], v[152:155], v[32:47]
    buffer_load_dwordx4 v3, s[12:15], s68 offen offset:1024 lds
    v_exp_f32 v21, v21
    ds_read_b64_tr_b16 v[88:89], v8 offset:6144
    ds_read_b64_tr_b16 v[90:91], v8 offset:6656
    v_mfma_f32_32x32x16_bf16 v[32:47], v[92:95], v[156:159], v[32:47]
    v_fma_f32 v20, v20, v14, v14
    v_fma_f32 v21, v21, v14, v14
    v_rcp_f32 v20, v20
    ds_read_b64_tr_b16 v[92:93], v9 offset:0
    ds_read_b64_tr_b16 v[94:95], v9 offset:512
    s_waitcnt lgkmcnt(6)
    v_mfma_f32_32x32x16_bf16 v[32:47], v[96:99], v[160:163], v[32:47]
    buffer_load_dwordx4 v4, s[12:15], s68 offen offset:2048 lds
    v_rcp_f32 v21, v21
    ds_read_b64_tr_b16 v[96:97], v9 offset:2048
    ds_read_b64_tr_b16 v[98:99], v9 offset:2560
    v_mfma_f32_32x32x16_bf16 v[32:47], v[80:83], v[164:167], v[32:47]
    ds_write_b64 v112, v[114:115] offset:36864
    ds_write_b64 v112, v[114:115] offset:35840
    ds_write_b32 v26, v26 offset:34816
    v_mul_f32 v58, v58, v20
    v_mul_f32 v59, v59, v21
    ds_read_b64_tr_b16 v[80:81], v9 offset:4096
    ds_read_b64_tr_b16 v[82:83], v9 offset:4608
    s_waitcnt lgkmcnt(9)
    v_mfma_f32_32x32x16_bf16 v[32:47], v[84:87], v[168:171], v[32:47]
    buffer_load_dwordx4 v5, s[12:15], s68 offen offset:3072 lds
    v_mul_f32 v20, v60, v60
    v_mul_f32 v21, v61, v61
    s_waitcnt lgkmcnt(2)
    s_barrier
    ds_read_b64_tr_b16 v[84:85], v9 offset:6144
    ds_read_b64_tr_b16 v[86:87], v9 offset:6656
    s_mov_b64 exec, 1
    buffer_store_dword v31, v10, s[20:23], s49 offen offset:0 sc1
    s_mov_b64 exec, -1
    v_mfma_f32_32x32x16_bf16 v[32:47], v[88:91], v[172:175], v[32:47]
    v_fma_f32 v20, v20, v13, v12
    v_fma_f32 v21, v21, v13, v12
    v_mul_f32 v20, v20, v60
    v_mul_f32 v21, v21, v61
    ds_read_b64_tr_b16 v[88:89], v6 offset:8192
    ds_read_b64_tr_b16 v[90:91], v6 offset:8704
    v_mfma_f32_32x32x16_bf16 v[32:47], v[92:95], v[176:179], v[32:47]
    v_exp_f32 v20, v20
    v_exp_f32 v21, v21
    ds_read_b64_tr_b16 v[92:93], v6 offset:10240
    ds_read_b64_tr_b16 v[94:95], v6 offset:10752
    v_mfma_f32_32x32x16_bf16 v[32:47], v[96:99], v[180:183], v[32:47]
    s_add_u32 m0, s70, 24576
    s_nop 0
    buffer_load_dwordx4 v2, s[12:15], s69 offen offset:0 lds
    v_fma_f32 v20, v20, v14, v14
    ds_read_b64_tr_b16 v[96:97], v6 offset:12288
    ds_read_b64_tr_b16 v[98:99], v6 offset:12800
    s_waitcnt lgkmcnt(6)
    v_mfma_f32_32x32x16_bf16 v[32:47], v[80:83], v[184:187], v[32:47]
    v_fma_f32 v21, v21, v14, v14
    v_rcp_f32 v20, v20
    v_rcp_f32 v21, v21
    ds_read_b64_tr_b16 v[80:81], v6 offset:14336
    ds_read_b64_tr_b16 v[82:83], v6 offset:14848
    v_mfma_f32_32x32x16_bf16 v[32:47], v[84:87], v[188:191], v[32:47]
    v_mul_f32 v60, v60, v20
    v_mul_f32 v61, v61, v21
    v_mul_f32 v20, v62, v62
    ds_read_b64_tr_b16 v[84:85], v7 offset:8192
    ds_read_b64_tr_b16 v[86:87], v7 offset:8704
    s_waitcnt lgkmcnt(6)
    v_mfma_f32_16x16x32_bf16 v[122:125], v[118:121], v[88:91], v[122:125]
    v_mfma_f32_32x32x16_bf16 v[32:47], v[88:91], v[192:195], v[32:47]
    buffer_load_dwordx4 v3, s[12:15], s69 offen offset:1024 lds
    v_mul_f32 v21, v63, v63
    v_fma_f32 v20, v20, v13, v12
    ds_read_b64_tr_b16 v[88:89], v7 offset:10240
    ds_read_b64_tr_b16 v[90:91], v7 offset:10752
    v_mfma_f32_16x16x32_bf16 v[122:125], v[118:121], v[92:95], v[122:125]
    v_mfma_f32_32x32x16_bf16 v[32:47], v[92:95], v[196:199], v[32:47]
    v_fma_f32 v21, v21, v13, v12
    v_mul_f32 v20, v20, v62
    v_mul_f32 v21, v21, v63
    v_exp_f32 v20, v20
    ds_read_b64_tr_b16 v[92:93], v7 offset:12288
    ds_read_b64_tr_b16 v[94:95], v7 offset:12800
    s_waitcnt lgkmcnt(6)
    v_mfma_f32_16x16x32_bf16 v[122:125], v[118:121], v[96:99], v[122:125]
    v_mfma_f32_32x32x16_bf16 v[32:47], v[96:99], v[200:203], v[32:47]
    v_exp_f32 v21, v21
    v_fma_f32 v20, v20, v14, v14
    ds_read_b64_tr_b16 v[96:97], v7 offset:14336
    ds_read_b64_tr_b16 v[98:99], v7 offset:14848
    v_mfma_f32_16x16x32_bf16 v[122:125], v[118:121], v[80:83], v[122:125]
    v_mfma_f32_32x32x16_bf16 v[32:47], v[80:83], v[204:207], v[32:47]
    buffer_load_dwordx4 v4, s[12:15], s69 offen offset:2048 lds
    v_fma_f32 v21, v21, v14, v14
    ds_read_b64_tr_b16 v[80:81], v8 offset:8192
    ds_read_b64_tr_b16 v[82:83], v8 offset:8704
    s_waitcnt lgkmcnt(6)
    v_mfma_f32_32x32x16_bf16 v[32:47], v[84:87], v[208:211], v[32:47]
    v_rcp_f32 v20, v20
    v_rcp_f32 v21, v21
    v_mul_f32 v62, v62, v20
    ds_read_b64_tr_b16 v[84:85], v8 offset:10240
    ds_read_b64_tr_b16 v[86:87], v8 offset:10752
    v_mfma_f32_32x32x16_bf16 v[32:47], v[88:91], v[212:215], v[32:47]
    v_mul_f32 v63, v63, v21
    v_mul_f32 v64, v64, v48
    v_mul_f32 v65, v65, v49
    v_cvt_pk_bf16_f32 v48, v64, v65
    v_mul_f32 v66, v66, v50
    ds_read_b64_tr_b16 v[88:89], v8 offset:12288
    ds_read_b64_tr_b16 v[90:91], v8 offset:12800
    s_waitcnt lgkmcnt(6)
    v_mfma_f32_32x32x16_bf16 v[32:47], v[92:95], v[216:219], v[32:47]
    buffer_load_dwordx4 v5, s[12:15], s69 offen offset:3072 lds
    v_mul_f32 v67, v67, v51
    ds_read_b64_tr_b16 v[92:93], v8 offset:14336
    ds_read_b64_tr_b16 v[94:95], v8 offset:14848
    v_mfma_f32_32x32x16_bf16 v[32:47], v[96:99], v[220:223], v[32:47]
    ds_write_b32 v126, v122 offset:512
    v_cvt_pk_bf16_f32 v49, v66, v67
    v_mul_f32 v68, v68, v52
    v_mul_f32 v69, v69, v53
    v_cvt_pk_bf16_f32 v50, v68, v69
    ds_read_b64_tr_b16 v[96:97], v9 offset:8192
    ds_read_b64_tr_b16 v[98:99], v9 offset:8704
    s_waitcnt lgkmcnt(7)
    v_mfma_f32_32x32x16_bf16 v[32:47], v[80:83], v[224:227], v[32:47]
    v_mul_f32 v70, v70, v54
    v_mul_f32 v71, v71, v55
    v_cvt_pk_bf16_f32 v51, v70, v71
    ds_read_b64_tr_b16 v[80:81], v9 offset:10240
    ds_read_b64_tr_b16 v[82:83], v9 offset:10752
    v_mfma_f32_32x32x16_bf16 v[32:47], v[84:87], v[228:231], v[32:47]
    buffer_store_dwordx4 v[48:51], v10, s[20:23], s41 offen offset:0 sc1
    v_mul_f32 v72, v72, v56
    v_mul_f32 v73, v73, v57
    ds_read_b64_tr_b16 v[84:85], v9 offset:12288
    ds_read_b64_tr_b16 v[86:87], v9 offset:12800
    s_waitcnt lgkmcnt(7)
    v_mfma_f32_32x32x16_bf16 v[32:47], v[88:91], v[232:235], v[32:47]
    v_cvt_pk_bf16_f32 v56, v72, v73
    v_mul_f32 v74, v74, v58
    v_mul_f32 v75, v75, v59
    v_cvt_pk_bf16_f32 v57, v74, v75
    v_mul_f32 v76, v76, v60
    s_waitcnt vmcnt(6)
    s_waitcnt lgkmcnt(6)
    s_barrier
    ds_read_b64_tr_b16 v[88:89], v9 offset:14336
    ds_read_b64_tr_b16 v[90:91], v9 offset:14848
    v_mfma_f32_32x32x16_bf16 v[32:47], v[92:95], v[236:239], v[32:47]
    ds_read_b128 v[16:19], v28 offset:512
    v_mul_f32 v77, v77, v61
    v_cvt_pk_bf16_f32 v58, v76, v77
    v_mul_f32 v78, v78, v62
    v_mul_f32 v79, v79, v63
    ds_read_b64_tr_b16 v[92:93], v6 offset:16384
    ds_read_b64_tr_b16 v[94:95], v6 offset:16896
    s_waitcnt lgkmcnt(7)
    v_mfma_f32_32x32x16_bf16 v[32:47], v[96:99], v[240:243], v[32:47]
    v_cvt_pk_bf16_f32 v59, v78, v79
    buffer_store_dwordx4 v[56:59], v10, s[20:23], s41 offen offset:1024 sc1
    ds_read_b64_tr_b16 v[96:97], v6 offset:18432
    ds_read_b64_tr_b16 v[98:99], v6 offset:18944
    v_mfma_f32_32x32x16_bf16 v[32:47], v[80:83], v[244:247], v[32:47]
    buffer_load_dword v111, v109, s[20:23], s58 offen
    s_waitcnt lgkmcnt(4)
    v_add_f32 v16, v16, v17
    v_add_f32 v18, v18, v19
    ds_read_b64_tr_b16 v[80:81], v6 offset:20480
    ds_read_b64_tr_b16 v[82:83], v6 offset:20992
    v_mfma_f32_32x32x16_bf16 v[32:47], v[84:87], v[248:251], v[32:47]
    v_add_f32 v16, v16, v18
    v_cvt_pk_bf16_f32 v117, v16, v16
    v_and_b32 v17, 0xffff0000, v117
    v_sub_f32 v17, v16, v17
    v_cvt_pk_bf16_f32 v116, v16, v17
    ds_read_b64_tr_b16 v[84:85], v6 offset:22528
    ds_read_b64_tr_b16 v[86:87], v6 offset:23040
    v_mfma_f32_32x32x16_bf16 v[32:47], v[88:91], v[252:255], v[32:47]
    v_mfma_f32_32x32x16_bf16 v[32:47], v[116:119], v[24:27], v[32:47]
    s_mul_i32 s73, s3, 81920
    v_add_u32 v2, s73, v10
    v_lshrrev_b32 v4, 5, v1
    v_and_b32 v5, 15, v1
    ds_read_b64_tr_b16 v[88:89], v7 offset:16384
    ds_read_b64_tr_b16 v[90:91], v7 offset:16896
    s_waitcnt lgkmcnt(6)
    v_mfma_f32_16x16x32_bf16 v[122:125], v[118:121], v[92:95], 0
    v_mfma_f32_32x32x16_bf16 v[48:63], v[92:95], v[128:131], 0
    v_lshlrev_b32 v5, 4, v5
    v_lshl_add_u32 v5, v4, 8, v5
    s_add_u32 s73, s73, 40960
    v_add_u32 v3, s73, v5
    ds_read_b64_tr_b16 v[92:93], v7 offset:18432
    ds_read_b64_tr_b16 v[94:95], v7 offset:18944
    v_mfma_f32_16x16x32_bf16 v[122:125], v[118:121], v[96:99], v[122:125]
    v_mfma_f32_32x32x16_bf16 v[48:63], v[96:99], v[132:135], v[48:63]
    v_add_u32 v5, 0x8c00, v5
    v_and_b32 v4, 16, v1
    ds_read_b64_tr_b16 v[96:97], v7 offset:20480
    ds_read_b64_tr_b16 v[98:99], v7 offset:20992
    s_waitcnt lgkmcnt(6)
    v_mfma_f32_16x16x32_bf16 v[122:125], v[118:121], v[80:83], v[122:125]
    v_mfma_f32_32x32x16_bf16 v[48:63], v[80:83], v[136:139], v[48:63]
    v_cmp_eq_u32 vcc, 16, v4
    v_mov_b32 v4, 4096
    s_nop 0
    v_cndmask_b32 v3, v3, v5, vcc
    v_cndmask_b32 v4, v4, 0, vcc
    v_and_b32 v5, 7, v0
    v_mul_f32 v20, v32, v32
    ds_read_b64_tr_b16 v[80:81], v7 offset:22528
    ds_read_b64_tr_b16 v[82:83], v7 offset:23040
    v_mfma_f32_16x16x32_bf16 v[122:125], v[118:121], v[84:87], v[122:125]
    v_mfma_f32_32x32x16_bf16 v[48:63], v[84:87], v[140:143], v[48:63]
    v_lshlrev_b32 v5, 4, v5
    v_lshrrev_b32 v113, 3, v0
    v_lshl_add_u32 v5, v113, 10, v5
    v_mul_f32 v21, v33, v33
    v_fma_f32 v20, v20, v13, v12
    v_fma_f32 v21, v21, v13, v12
    ds_read_b64_tr_b16 v[84:85], v8 offset:16384
    ds_read_b64_tr_b16 v[86:87], v8 offset:16896
    s_waitcnt lgkmcnt(6)
    v_mfma_f32_32x32x16_bf16 v[48:63], v[88:91], v[144:147], v[48:63]
    v_mul_f32 v20, v20, v32
    v_mul_f32 v21, v21, v33
    v_exp_f32 v20, v20
    v_exp_f32 v21, v21
    ds_read_b64_tr_b16 v[88:89], v8 offset:18432
    ds_read_b64_tr_b16 v[90:91], v8 offset:18944
    v_mfma_f32_32x32x16_bf16 v[48:63], v[92:95], v[148:151], v[48:63]
    v_fma_f32 v20, v20, v14, v14
    v_fma_f32 v21, v21, v14, v14
    v_rcp_f32 v20, v20
    v_rcp_f32 v21, v21
    ds_read_b64_tr_b16 v[92:93], v8 offset:20480
    ds_read_b64_tr_b16 v[94:95], v8 offset:20992
    s_waitcnt lgkmcnt(6)
    v_mfma_f32_32x32x16_bf16 v[48:63], v[96:99], v[152:155], v[48:63]
    v_mul_f32 v32, v32, v20
    v_mul_f32 v33, v33, v21
    v_mul_f32 v20, v34, v34
    v_mul_f32 v21, v35, v35
    v_fma_f32 v20, v20, v13, v12
    v_fma_f32 v21, v21, v13, v12
    ds_read_b64_tr_b16 v[96:97], v8 offset:22528
    ds_read_b64_tr_b16 v[98:99], v8 offset:23040
    v_mfma_f32_32x32x16_bf16 v[48:63], v[80:83], v[156:159], v[48:63]
    v_mul_f32 v20, v20, v34
    v_mul_f32 v21, v21, v35
    v_exp_f32 v20, v20
    v_exp_f32 v21, v21
    s_waitcnt vmcnt(0)
    v_cmp_ne_u32 vcc, s59, v111
    s_nop 0
    s_and_b64 vcc, vcc, s[52:53]
    s_cselect_b32 s87, 0x40000000, s54
    ds_read_b64_tr_b16 v[80:81], v9 offset:16384
    ds_read_b64_tr_b16 v[82:83], v9 offset:16896
    s_waitcnt lgkmcnt(6)
    v_mfma_f32_32x32x16_bf16 v[48:63], v[84:87], v[160:163], v[48:63]
    buffer_load_dword v112, v110, s[20:23], s58 offen
    s_add_u32 m0, s70, 0
    s_nop 0
    buffer_load_dwordx4 v10, s[20:23], s87 offen offset:0 lds
    ds_read_b64_tr_b16 v[84:85], v9 offset:18432
    ds_read_b64_tr_b16 v[86:87], v9 offset:18944
    v_mfma_f32_32x32x16_bf16 v[48:63], v[88:91], v[164:167], v[48:63]
    buffer_load_dwordx4 v10, s[20:23], s87 offen offset:1024 lds
    v_fma_f32 v20, v20, v14, v14
    v_fma_f32 v21, v21, v14, v14
    ds_read_b64_tr_b16 v[88:89], v9 offset:20480
    ds_read_b64_tr_b16 v[90:91], v9 offset:20992
    s_waitcnt lgkmcnt(6)
    v_mfma_f32_32x32x16_bf16 v[48:63], v[92:95], v[168:171], v[48:63]
    v_rcp_f32 v20, v20
    v_rcp_f32 v21, v21
    v_mul_f32 v34, v34, v20
    v_mul_f32 v35, v35, v21
    v_mul_f32 v20, v36, v36
    s_barrier
    ds_read_b64_tr_b16 v[92:93], v9 offset:22528
    ds_read_b64_tr_b16 v[94:95], v9 offset:23040
    v_mfma_f32_32x32x16_bf16 v[48:63], v[96:99], v[172:175], v[48:63]
    buffer_load_dwordx4 v10, s[20:23], s87 offen offset:2048 lds
    v_mul_f32 v21, v37, v37
    v_fma_f32 v20, v20, v13, v12
    v_fma_f32 v21, v21, v13, v12
    ds_read_b64_tr_b16 v[96:97], v6 offset:24576
    ds_read_b64_tr_b16 v[98:99], v6 offset:25088
    s_waitcnt lgkmcnt(6)
    v_mfma_f32_32x32x16_bf16 v[48:63], v[80:83], v[176:179], v[48:63]
    v_mul_f32 v20, v20, v36
    v_mul_f32 v21, v21, v37
    v_exp_f32 v20, v20
    v_exp_f32 v21, v21
    ds_read_b64_tr_b16 v[80:81], v6 offset:26624
    ds_read_b64_tr_b16 v[82:83], v6 offset:27136
    v_mfma_f32_32x32x16_bf16 v[48:63], v[84:87], v[180:183], v[48:63]
    buffer_load_dwordx4 v10, s[20:23], s87 offen offset:3072 lds
    v_fma_f32 v20, v20, v14, v14
    v_fma_f32 v21, v21, v14, v14
    v_rcp_f32 v20, v20
    ds_read_b64_tr_b16 v[84:85], v6 offset:28672
    ds_read_b64_tr_b16 v[86:87], v6 offset:29184
    s_waitcnt lgkmcnt(6)
    v_mfma_f32_32x32x16_bf16 v[48:63], v[88:91], v[184:187], v[48:63]
    v_rcp_f32 v21, v21
    v_mul_f32 v36, v36, v20
    v_mul_f32 v37, v37, v21
    v_mul_f32 v20, v38, v38
    ds_read_b64_tr_b16 v[88:89], v6 offset:30720
    ds_read_b64_tr_b16 v[90:91], v6 offset:31232
    v_mfma_f32_32x32x16_bf16 v[48:63], v[92:95], v[188:191], v[48:63]
    v_mul_f32 v21, v39, v39
    v_fma_f32 v20, v20, v13, v12
    v_fma_f32 v21, v21, v13, v12
    v_mul_f32 v20, v20, v38
    v_mul_f32 v21, v21, v39
    v_exp_f32 v20, v20
    ds_read_b64_tr_b16 v[92:93], v7 offset:24576
    ds_read_b64_tr_b16 v[94:95], v7 offset:25088
    s_waitcnt lgkmcnt(6)
    v_mfma_f32_16x16x32_bf16 v[122:125], v[118:121], v[96:99], v[122:125]
    v_mfma_f32_32x32x16_bf16 v[48:63], v[96:99], v[192:195], v[48:63]
    v_exp_f32 v21, v21
    v_fma_f32 v20, v20, v14, v14
    v_fma_f32 v21, v21, v14, v14
    v_rcp_f32 v20, v20
    ds_read_b64_tr_b16 v[96:97], v7 offset:26624
    ds_read_b64_tr_b16 v[98:99], v7 offset:27136
    v_mfma_f32_16x16x32_bf16 v[122:125], v[118:121], v[80:83], v[122:125]
    v_mfma_f32_32x32x16_bf16 v[48:63], v[80:83], v[196:199], v[48:63]
    v_rcp_f32 v21, v21
    v_mul_f32 v38, v38, v20
    v_mul_f32 v39, v39, v21
    v_mul_f32 v20, v40, v40
    ds_read_b64_tr_b16 v[80:81], v7 offset:28672
    ds_read_b64_tr_b16 v[82:83], v7 offset:29184
    s_waitcnt lgkmcnt(6)
    v_mfma_f32_16x16x32_bf16 v[122:125], v[118:121], v[84:87], v[122:125]
    v_mfma_f32_32x32x16_bf16 v[48:63], v[84:87], v[200:203], v[48:63]
    s_waitcnt vmcnt(4)
    v_cmp_ne_u32 vcc, s59, v112
    s_nop 0
    s_andn2_b64 vcc, vcc, s[52:53]
    s_cselect_b32 s88, 0x40000000, s55
    buffer_load_dwordx4 v[100:103], v10, s[20:23], s88 offen
    buffer_load_dwordx4 v[104:107], v10, s[20:23], s88 offen offset:1024
    ds_read_b64_tr_b16 v[84:85], v7 offset:30720
    ds_read_b64_tr_b16 v[86:87], v7 offset:31232
    v_mfma_f32_16x16x32_bf16 v[122:125], v[118:121], v[88:91], v[122:125]
    v_mfma_f32_32x32x16_bf16 v[48:63], v[88:91], v[204:207], v[48:63]
    v_mul_f32 v21, v41, v41
    v_fma_f32 v20, v20, v13, v12
    v_fma_f32 v21, v21, v13, v12
    v_mul_f32 v20, v20, v40
    v_mul_f32 v21, v21, v41
    v_exp_f32 v20, v20
    ds_read_b64_tr_b16 v[88:89], v8 offset:24576
    ds_read_b64_tr_b16 v[90:91], v8 offset:25088
    s_waitcnt lgkmcnt(6)
    v_mfma_f32_32x32x16_bf16 v[48:63], v[92:95], v[208:211], v[48:63]
    v_exp_f32 v21, v21
    v_fma_f32 v20, v20, v14, v14
    v_fma_f32 v21, v21, v14, v14
    v_rcp_f32 v20, v20
    ds_read_b64_tr_b16 v[92:93], v8 offset:26624
    ds_read_b64_tr_b16 v[94:95], v8 offset:27136
    v_mfma_f32_32x32x16_bf16 v[48:63], v[96:99], v[212:215], v[48:63]
    s_add_u32 m0, s70, 8192
    s_add_u32 s87, s87, 8192
    buffer_load_dwordx4 v10, s[20:23], s87 offen offset:0 lds
    v_rcp_f32 v21, v21
    ds_read_b64_tr_b16 v[96:97], v8 offset:28672
    ds_read_b64_tr_b16 v[98:99], v8 offset:29184
    s_waitcnt lgkmcnt(6)
    v_mfma_f32_32x32x16_bf16 v[48:63], v[80:83], v[216:219], v[48:63]
    s_or_b32 s89, s87, s88
    s_bitcmp1_b32 s89, 30
    s_cselect_b32 s89, s58, 0x40000000
    buffer_load_dword v127, v108, s[20:23], s89 offen sc1
    s_setprio 3
    v_mul_f32 v40, v40, v20
    ds_read_b64_tr_b16 v[80:81], v8 offset:30720
    ds_read_b64_tr_b16 v[82:83], v8 offset:31232
    v_mfma_f32_32x32x16_bf16 v[48:63], v[84:87], v[220:223], v[48:63]
    buffer_load_dwordx4 v10, s[20:23], s87 offen offset:1024 lds
    ds_write_b32 v126, v122 offset:0
    v_mul_f32 v41, v41, v21
    v_mul_f32 v20, v42, v42
    v_mul_f32 v21, v43, v43
    ds_read_b64_tr_b16 v[84:85], v9 offset:24576
    ds_read_b64_tr_b16 v[86:87], v9 offset:25088
    s_waitcnt lgkmcnt(7)
    v_mfma_f32_32x32x16_bf16 v[48:63], v[88:91], v[224:227], v[48:63]
    v_fma_f32 v20, v20, v13, v12
    v_fma_f32 v21, v21, v13, v12
    v_mul_f32 v20, v20, v42
    v_mul_f32 v21, v21, v43
    v_exp_f32 v20, v20
    ds_read_b64_tr_b16 v[88:89], v9 offset:26624
    ds_read_b64_tr_b16 v[90:91], v9 offset:27136
    v_mfma_f32_32x32x16_bf16 v[48:63], v[92:95], v[228:231], v[48:63]
    buffer_load_dwordx4 v10, s[20:23], s87 offen offset:2048 lds
    v_exp_f32 v21, v21
    v_fma_f32 v20, v20, v14, v14
    ds_read_b64_tr_b16 v[92:93], v9 offset:28672
    ds_read_b64_tr_b16 v[94:95], v9 offset:29184
    s_waitcnt lgkmcnt(7)
    v_mfma_f32_32x32x16_bf16 v[48:63], v[96:99], v[232:235], v[48:63]
    v_fma_f32 v21, v21, v14, v14
    v_rcp_f32 v20, v20
    v_rcp_f32 v21, v21
    v_mul_f32 v42, v42, v20
    s_waitcnt lgkmcnt(6)
    s_barrier
    ds_read_b64_tr_b16 v[96:97], v9 offset:30720
    ds_read_b64_tr_b16 v[98:99], v9 offset:31232
    v_mfma_f32_32x32x16_bf16 v[48:63], v[80:83], v[236:239], v[48:63]
    buffer_load_dwordx4 v10, s[20:23], s87 offen offset:3072 lds
    ds_read_b128 v[16:19], v28 offset:0
    v_mul_f32 v43, v43, v21
    v_mul_f32 v20, v44, v44
    s_waitcnt lgkmcnt(5)
    v_mfma_f32_32x32x16_bf16 v[48:63], v[84:87], v[240:243], v[48:63]
    s_bitcmp0_b32 s87, 30
    s_cselect_b32 s72, 1, 0
    v_mov_b32 v113, s72
    s_waitcnt vmcnt(7)
    s_mov_b64 exec, 1
    ds_add_u32 v26, v113 offset:34816
    s_mov_b64 exec, -1
    v_mul_f32 v21, v45, v45
    v_fma_f32 v20, v20, v13, v12
    v_fma_f32 v21, v21, v13, v12
    v_mul_f32 v20, v20, v44
    v_mul_f32 v21, v21, v45
    v_exp_f32 v20, v20
    v_mfma_f32_32x32x16_bf16 v[48:63], v[88:91], v[244:247], v[48:63]
    s_waitcnt lgkmcnt(1)
    v_add_f32 v16, v16, v17
    v_add_f32 v18, v18, v19
    v_add_f32 v16, v16, v18
    v_exp_f32 v21, v21
    v_mfma_f32_32x32x16_bf16 v[48:63], v[92:95], v[248:251], v[48:63]
    v_cvt_pk_bf16_f32 v117, v16, v16
    v_and_b32 v17, 0xffff0000, v117
    v_sub_f32 v17, v16, v17
    v_cvt_pk_bf16_f32 v116, v16, v17
    v_fma_f32 v20, v20, v14, v14
    v_fma_f32 v21, v21, v14, v14
    v_mfma_f32_32x32x16_bf16 v[48:63], v[96:99], v[252:255], v[48:63]
    v_mfma_f32_32x32x16_bf16 v[48:63], v[116:119], v[24:27], v[48:63]
    v_rcp_f32 v20, v20
    v_rcp_f32 v21, v21
    v_mul_f32 v44, v44, v20
    v_mul_f32 v45, v45, v21
    v_mul_f32 v20, v46, v46
    v_mul_f32 v21, v47, v47
    v_fma_f32 v20, v20, v13, v12
    v_fma_f32 v21, v21, v13, v12
    v_mul_f32 v20, v20, v46
    v_mul_f32 v21, v21, v47
    v_exp_f32 v20, v20
    v_exp_f32 v21, v21
    v_fma_f32 v20, v20, v14, v14
    v_fma_f32 v21, v21, v14, v14
    v_rcp_f32 v20, v20
    v_rcp_f32 v21, v21
    v_mul_f32 v46, v46, v20
    v_mul_f32 v47, v47, v21
    v_mul_f32 v48, v48, v32
    v_mul_f32 v49, v49, v33
    v_cvt_pk_bf16_f32 v32, v48, v49
    v_mul_f32 v50, v50, v34
    v_mul_f32 v51, v51, v35
    v_cvt_pk_bf16_f32 v33, v50, v51
    v_mul_f32 v52, v52, v36
    v_mul_f32 v53, v53, v37
    v_cvt_pk_bf16_f32 v34, v52, v53
    v_mul_f32 v54, v54, v38
    v_mul_f32 v55, v55, v39
    v_cvt_pk_bf16_f32 v35, v54, v55
    buffer_store_dwordx4 v[32:35], v10, s[20:23], s42 offen offset:0 sc1
    v_mul_f32 v56, v56, v40
    ds_read_b32 v114, v26 offset:34816
    v_mul_f32 v57, v57, v41
    v_cvt_pk_bf16_f32 v40, v56, v57
    v_mul_f32 v58, v58, v42
    v_mul_f32 v59, v59, v43
    v_cvt_pk_bf16_f32 v41, v58, v59
    v_mul_f32 v60, v60, v44
    v_mul_f32 v61, v61, v45
    v_cvt_pk_bf16_f32 v42, v60, v61
    v_mul_f32 v62, v62, v46
    v_mul_f32 v63, v63, v47
    v_cvt_pk_bf16_f32 v43, v62, v63
    buffer_store_dwordx4 v[40:43], v10, s[20:23], s42 offen offset:1024 sc1
    s_or_b32 s72, s87, s88
    s_bitcmp1_b32 s72, 30
    s_cbranch_scc0 K1a_havekv
    s_waitcnt vmcnt(5)
    v_cmp_ne_u32 vcc, s59, v127
    s_nop 0
    s_andn2_b64 vcc, vcc, s[52:53]
    s_nop 2
    s_cbranch_vccz K1a_fq1
    s_mov_b32 s74, 262144
K1a_fq0:
    buffer_load_dword v127, v108, s[20:23], s58 offen sc1
    s_waitcnt vmcnt(0)
    v_cmp_ne_u32 vcc, s59, v127
    s_nop 0
    s_andn2_b64 vcc, vcc, s[52:53]
    s_nop 2
    s_cbranch_vccz K1a_fq1
    s_sub_u32 s74, s74, 1
    s_cbranch_scc0 K1a_fq0
K1a_fq1:
    s_mov_b32 s88, s55
    buffer_load_dwordx4 v[100:103], v10, s[20:23], s88 offen
    buffer_load_dwordx4 v[104:107], v10, s[20:23], s88 offen offset:1024
    s_bitcmp1_b32 s87, 30
    s_cbranch_scc0 K1a_kvok
    v_cmp_ne_u32 vcc, s59, v127
    s_nop 0
    s_and_b64 vcc, vcc, s[52:53]
    s_nop 2
    s_cbranch_vccz K1a_fl1
    s_mov_b32 s74, 262144
K1a_fl0:
    buffer_load_dword v127, v108, s[20:23], s58 offen sc1
    s_waitcnt vmcnt(0)
    v_cmp_ne_u32 vcc, s59, v127
    s_nop 0
    s_and_b64 vcc, vcc, s[52:53]
    s_nop 2
    s_cbranch_vccz K1a_fl1
    s_sub_u32 s74, s74, 1
    s_cbranch_scc0 K1a_fl0
K1a_fl1:
    s_mov_b32 s87, s54
    s_add_u32 m0, s70, 0
    s_nop 0
    buffer_load_dwordx4 v10, s[20:23], s87 offen offset:0 lds
    buffer_load_dwordx4 v10, s[20:23], s87 offen offset:1024 lds
    buffer_load_dwordx4 v10, s[20:23], s87 offen offset:2048 lds
    buffer_load_dwordx4 v10, s[20:23], s87 offen offset:3072 lds
    s_add_u32 m0, s70, 8192
    s_add_u32 s87, s87, 8192
    buffer_load_dwordx4 v10, s[20:23], s87 offen offset:0 lds
    buffer_load_dwordx4 v10, s[20:23], s87 offen offset:1024 lds
    buffer_load_dwordx4 v10, s[20:23], s87 offen offset:2048 lds
    buffer_load_dwordx4 v10, s[20:23], s87 offen offset:3072 lds
    v_mov_b32 v113, 1
    s_waitcnt vmcnt(4)
    s_mov_b64 exec, 1
    ds_add_u32 v26, v113 offset:34816
    s_mov_b64 exec, -1
K1a_kvok:
    s_waitcnt vmcnt(0)
K1a_havekv:
    s_add_u32 s54, s54, 8192
    s_waitcnt vmcnt(7)
K1a_end:
    s_branch K2_start
K_exit0:
    s_endpgm
.p2align 6
K1_typeB:
    s_lshl_b32 s35, s35, 1
    s_add_u32 s34, s34, s35
    s_cmp_lg_u32 s32, 4
    s_cbranch_scc1 K1b_c0
    s_getpc_b64 s[98:99]
K1b_pc:
    s_and_b32 s72, s33, 1
    s_lshl_b32 s72, s72, 13
    v_lshl_add_u32 v44, v1, 7, s72
    v_min_u32 v44, K1b_end-K1b_pc, v44
    global_load_dword v31, v44, s[98:99]
K1b_c0:
    v_lshrrev_b32 v40, 3, v1
    v_and_b32 v41, 7, v1
    v_lshrrev_b32 v42, 1, v40
    v_xor_b32 v43, v41, v42
    v_lshlrev_b32 v43, 4, v43
    v_lshl_add_u32 v106, v40, 10, v43
    v_xor_b32 v107, 64, v106
    v_add_u32 v107, 7168, v107
    v_add_u32 v108, 14336, v106
    v_add_u32 v109, 14336, v107
    s_and_b32 s35, s32, 3
    s_lshr_b32 s3, s32, 2
    s_lshl_b32 s75, s33, 2
    s_add_u32 s75, s75, s35
    s_lshl_b32 s98, s75, 15
    s_mul_i32 s94, s35, 40960
    s_lshl_b32 s72, s3, 14
    s_add_u32 s71, s94, s72
    s_add_u32 s71, s71, 16384
    s_lshl_b32 s72, s3, 12
    s_add_u32 s70, s94, s72
    s_lshr_b32 s97, s2, 5
    s_lshl_b32 s99, s3, 1
    s_xor_b32 s99, s99, s35
    s_add_u32 s77, s99, s97
    s_xor_b32 s78, s99, 1
    s_add_u32 s78, s78, s97
    s_and_b32 s77, s77, 7
    s_and_b32 s78, s78, 7
    s_lshl_b32 s77, s77, 7
    s_lshl_b32 s78, s78, 7
    s_add_u32 s77, s77, s98
    s_add_u32 s78, s78, s98
    s_mov_b32 s6, 2097152
    s_mov_b32 s7, 0x00020000
    s_waitcnt lgkmcnt(0)
    s_mov_b32 s4, s36
    s_mov_b32 s5, s37
    s_add_u32 m0, s71, 0
    s_nop 0
    buffer_load_dwordx4 v106, s[4:7], s77 offen offset:0 lds
    buffer_load_dwordx4 v107, s[4:7], s77 offen offset:1024 lds
    buffer_load_dwordx4 v108, s[4:7], s77 offen offset:2048 lds
    buffer_load_dwordx4 v109, s[4:7], s77 offen offset:3072 lds
    s_add_u32 m0, s71, 4096
    s_nop 0
    buffer_load_dwordx4 v106, s[4:7], s78 offen offset:0 lds
    v_mul_u32_u24 v77, 3072, v1
    v_mul_u32_u24 v76, 3584, v1
    v_add_u32 v77, 4096, v77
    v_add_u32 v76, 4096, v76
    s_and_b32 s74, s33, 3
    s_add_u32 s72, s97, s35
    s_lshl_b32 s72, s72, 1
    s_add_u32 s72, s72, s3
    s_and_b32 s72, s72, 15
    s_xor_b32 s73, s72, 8
    s_mul_i32 s94, s72, 114688
    s_mul_i32 s95, s73, 114688
    s_mul_i32 s72, s72, 98304
    s_mul_i32 s73, s73, 98304
    s_lshl_b32 s96, s34, 8
    s_add_u32 s96, s96, 2048
    s_add_u32 s60, s72, s96
    s_add_u32 s62, s73, s96
    s_add_u32 s61, s60, 128
    s_add_u32 s63, s62, 128
    s_add_u32 s81, s34, 4
    s_lshl_b32 s96, s81, 7
    s_add_u32 s64, s72, s96
    s_add_u32 s65, s73, s96
    s_add_u32 s96, s96, 2560
    s_add_u32 s66, s94, s96
    s_add_u32 s67, s95, s96
    s_mov_b32 s68, s66
    s_mov_b32 s69, s67
    s_mul_i32 s95, s33, 98304
    s_sub_u32 s95, s95, s72
    s_mul_i32 s96, s33, 114688
    s_sub_u32 s96, s96, s94
    s_add_u32 s84, s60, s95
    s_add_u32 s85, s61, s95
    s_add_u32 s86, s64, s95
    s_add_u32 s79, s66, s96
    s_mov_b32 s80, s79
    s_and_b32 s73, s33, 3
    s_add_u32 s73, s73, s97
    s_and_b32 s73, s73, 7
    s_mul_i32 s73, s73, 196608
    s_sub_u32 s94, s60, s72
    s_add_u32 s94, s94, s73
    s_waitcnt lgkmcnt(0)
    s_sub_u32 s16, s38, 4096
    s_subb_u32 s17, s39, 0
    s_mov_b32 s18, 1576960
    s_mov_b32 s19, 0x00020000
    s_sub_u32 s8, s44, 4096
    s_subb_u32 s9, s45, 0
    s_mov_b32 s10, 1839104
    s_mov_b32 s11, 0x00020000
    s_sub_u32 s12, s46, 4096
    s_subb_u32 s13, s47, 0
    s_mov_b32 s14, 1839104
    s_mov_b32 s15, 0x00020000
    v_lshrrev_b32 v69, 3, v1
    v_bfe_u32 v70, v1, 4, 1
    v_lshlrev_b32 v70, 2, v70
    v_xor_b32 v70, v70, v1
    v_and_b32 v70, 7, v70
    v_lshlrev_b32 v70, 4, v70
    v_mul_u32_u24 v69, 3072, v69
    v_add_u32 v71, v69, v70
    s_xor_b32 s72, s74, 0
    s_mul_i32 s72, s72, 24576
    s_add_u32 s72, s72, 4096
    v_add_u32 v68, s72, v71
    s_xor_b32 s72, s74, 1
    s_mul_i32 s72, s72, 24576
    s_add_u32 s72, s72, 3072
    v_add_u32 v69, s72, v71
    s_xor_b32 s72, s74, 2
    s_mul_i32 s72, s72, 24576
    s_add_u32 s72, s72, 2048
    v_add_u32 v70, s72, v71
    s_xor_b32 s72, s74, 3
    s_mul_i32 s72, s72, 24576
    s_add_u32 s72, s72, 1024
    v_add_u32 v71, s72, v71
    v_lshrrev_b32 v3, 3, v1
    v_bfe_u32 v4, v1, 4, 1
    v_lshlrev_b32 v4, 2, v4
    v_xor_b32 v4, v4, v1
    v_and_b32 v4, 7, v4
    v_lshlrev_b32 v4, 4, v4
    v_mul_u32_u24 v3, 3584, v3
    v_add_u32 v5, v3, v4
    s_xor_b32 s72, s74, 0
    s_mul_i32 s72, s72, 28672
    s_add_u32 s72, s72, 4096
    v_add_u32 v2, s72, v5
    s_xor_b32 s72, s74, 1
    s_mul_i32 s72, s72, 28672
    s_add_u32 s72, s72, 3072
    v_add_u32 v3, s72, v5
    s_xor_b32 s72, s74, 2
    s_mul_i32 s72, s72, 28672
    s_add_u32 s72, s72, 2048
    v_add_u32 v4, s72, v5
    s_xor_b32 s72, s74, 3
    s_mul_i32 s72, s72, 28672
    s_add_u32 s72, s72, 1024
    v_add_u32 v5, s72, v5
    s_mov_b32 s20, s58
    s_mov_b32 s21, s59
    s_mov_b32 s22, 0x1600000
    s_mov_b32 s23, 0x00020000
    s_mov_b32 s28, s56
    s_mov_b32 s29, s57
    s_mov_b32 s30, 0x100
    s_mov_b32 s31, 0x00020000
    s_or_b32 s72, s2, s32
    s_cmp_lg_u32 s72, 0
    s_cbranch_scc1 K1b_nonon
    s_memrealtime s[100:101]
    v_mov_b32 v41, 0
    s_waitcnt lgkmcnt(0)
    s_or_b32 s72, s100, 1
    v_mov_b32 v40, s72
    s_mov_b64 exec, 1
    buffer_store_dword v40, v41, s[28:31], 0 offen sc1
    s_mov_b64 exec, -1
K1b_nonon:
    v_and_b32 v40, 31, v1
    v_lshrrev_b32 v41, 5, v1
    v_bfe_u32 v42, v1, 1, 3
    v_xor_b32 v42, v42, v41
    v_xor_b32 v42, s74, v42
    v_lshlrev_b32 v42, 4, v42
    v_lshl_add_u32 v42, v40, 7, v42
    s_lshl_b32 s72, s3, 15
    s_sub_u32 s72, s71, s72
    s_add_u32 s72, s72, 16384
    v_add_u32 v24, s71, v42
    v_add_u32 v100, s72, v42
    v_xor_b32 v25, 32, v24
    v_xor_b32 v26, 64, v24
    v_xor_b32 v27, 96, v24
    v_xor_b32 v101, 32, v100
    v_xor_b32 v102, 64, v100
    v_xor_b32 v103, 96, v100
    v_lshlrev_b32 v29, 12, v41
    v_lshl_add_u32 v29, v40, 2, v29
    v_lshlrev_b32 v10, 4, v1
    s_lshl_b32 s72, s3, 10
    s_add_u32 s72, s72, 32768
    v_lshl_add_u32 v28, v40, 4, s72
    s_lshl_b32 s72, s35, 2
    v_add_u32 v126, s72, v28
    s_mul_i32 s72, s35, 40960
    s_add_u32 s72, s72, 36864
    s_lshl_b32 s73, s3, 9
    s_add_u32 s72, s72, s73
    v_lshl_add_u32 v104, v1, 3, s72
    v_xor_b32 v105, 512, v104
    v_bfe_u32 v40, v1, 2, 2
    v_lshl_add_u32 v42, v41, 3, v40
    v_lshlrev_b32 v42, 7, v42
    v_lshrrev_b32 v40, 1, v40
    v_xor_b32 v40, s3, v40
    v_lshl_add_u32 v42, v40, 6, v42
    v_bfe_u32 v40, v1, 4, 1
    v_lshl_add_u32 v42, v40, 5, v42
    v_and_b32 v43, 7, v1
    v_lshlrev_b32 v40, 2, v40
    v_cmp_eq_u32 vcc, v40, v43
    v_and_b32 v40, 3, v1
    v_lshl_add_u32 v42, v40, 3, v42
    s_mov_b32 s76, 0x3f803f80
    v_mov_b32 v43, s76
    v_cndmask_b32 v118, 0, v43, vcc
    s_xor_b32 s72, s99, 0
    s_mul_i32 s72, s72, 40960
    v_add_u32 v6, s72, v42
    v_mov_b32 v16, 0
    v_cndmask_b32 v119, 0, v43, vcc
    s_xor_b32 s72, s99, 1
    s_mul_i32 s72, s72, 40960
    v_add_u32 v7, s72, v42
    v_mov_b32 v17, 0
    v_cndmask_b32 v120, 0, v43, vcc
    s_xor_b32 s72, s99, 2
    s_mul_i32 s72, s72, 40960
    v_add_u32 v8, s72, v42
    v_mov_b32 v18, 0
    v_cndmask_b32 v121, 0, v43, vcc
    s_xor_b32 s72, s99, 3
    s_mul_i32 s72, s72, 40960
    v_add_u32 v9, s72, v42
    v_mov_b32 v19, 0
    buffer_load_dwordx4 v107, s[4:7], s78 offen offset:1024 lds
    buffer_load_dwordx4 v108, s[4:7], s78 offen offset:2048 lds
    buffer_load_dwordx4 v109, s[4:7], s78 offen offset:3072 lds
    s_add_u32 m0, s70, 8192
    s_nop 0
    buffer_load_dwordx4 v68, s[16:19], s60 offen offset:0 lds
    buffer_load_dwordx4 v69, s[16:19], s60 offen offset:1024 lds
    buffer_load_dwordx4 v70, s[16:19], s60 offen offset:2048 lds
    buffer_load_dwordx4 v71, s[16:19], s60 offen offset:3072 lds
    s_waitcnt vmcnt(8)
    ds_read_b128 v[128:131], v24 offset:0
    ds_read_b128 v[132:135], v25 offset:0
    ds_read_b128 v[136:139], v26 offset:0
    ds_read_b128 v[140:143], v27 offset:0
    s_waitcnt lgkmcnt(0)
    v_dot2_f32_bf16 v16, v128, s76, v16
    v_dot2_f32_bf16 v18, v128, v128, v18
    v_dot2_f32_bf16 v17, v129, s76, v17
    v_dot2_f32_bf16 v19, v129, v129, v19
    v_dot2_f32_bf16 v16, v130, s76, v16
    v_dot2_f32_bf16 v18, v130, v130, v18
    v_dot2_f32_bf16 v17, v131, s76, v17
    v_dot2_f32_bf16 v19, v131, v131, v19
    v_dot2_f32_bf16 v16, v132, s76, v16
    v_dot2_f32_bf16 v18, v132, v132, v18
    v_dot2_f32_bf16 v17, v133, s76, v17
    v_dot2_f32_bf16 v19, v133, v133, v19
    v_dot2_f32_bf16 v16, v134, s76, v16
    v_dot2_f32_bf16 v18, v134, v134, v18
    v_dot2_f32_bf16 v17, v135, s76, v17
    v_dot2_f32_bf16 v19, v135, v135, v19
    v_dot2_f32_bf16 v16, v136, s76, v16
    v_dot2_f32_bf16 v18, v136, v136, v18
    v_dot2_f32_bf16 v17, v137, s76, v17
    v_dot2_f32_bf16 v19, v137, v137, v19
    v_dot2_f32_bf16 v16, v138, s76, v16
    v_dot2_f32_bf16 v18, v138, v138, v18
    v_dot2_f32_bf16 v17, v139, s76, v17
    v_dot2_f32_bf16 v19, v139, v139, v19
    v_dot2_f32_bf16 v16, v140, s76, v16
    v_dot2_f32_bf16 v18, v140, v140, v18
    v_dot2_f32_bf16 v17, v141, s76, v17
    v_dot2_f32_bf16 v19, v141, v141, v19
    v_dot2_f32_bf16 v16, v142, s76, v16
    v_dot2_f32_bf16 v18, v142, v142, v18
    v_dot2_f32_bf16 v17, v143, s76, v17
    v_dot2_f32_bf16 v19, v143, v143, v19
    s_waitcnt vmcnt(4)
    ds_read_b128 v[144:147], v24 offset:4096
    ds_read_b128 v[148:151], v25 offset:4096
    ds_read_b128 v[152:155], v26 offset:4096
    ds_read_b128 v[156:159], v27 offset:4096
    s_waitcnt lgkmcnt(0)
    v_dot2_f32_bf16 v16, v144, s76, v16
    v_dot2_f32_bf16 v18, v144, v144, v18
    v_dot2_f32_bf16 v17, v145, s76, v17
    v_dot2_f32_bf16 v19, v145, v145, v19
    v_dot2_f32_bf16 v16, v146, s76, v16
    v_dot2_f32_bf16 v18, v146, v146, v18
    v_dot2_f32_bf16 v17, v147, s76, v17
    v_dot2_f32_bf16 v19, v147, v147, v19
    v_dot2_f32_bf16 v16, v148, s76, v16
    v_dot2_f32_bf16 v18, v148, v148, v18
    v_dot2_f32_bf16 v17, v149, s76, v17
    v_dot2_f32_bf16 v19, v149, v149, v19
    v_dot2_f32_bf16 v16, v150, s76, v16
    v_dot2_f32_bf16 v18, v150, v150, v18
    v_dot2_f32_bf16 v17, v151, s76, v17
    v_dot2_f32_bf16 v19, v151, v151, v19
    v_dot2_f32_bf16 v16, v152, s76, v16
    v_dot2_f32_bf16 v18, v152, v152, v18
    v_dot2_f32_bf16 v17, v153, s76, v17
    v_dot2_f32_bf16 v19, v153, v153, v19
    v_dot2_f32_bf16 v16, v154, s76, v16
    v_dot2_f32_bf16 v18, v154, v154, v18
    v_dot2_f32_bf16 v17, v155, s76, v17
    v_dot2_f32_bf16 v19, v155, v155, v19
    v_dot2_f32_bf16 v16, v156, s76, v16
    v_dot2_f32_bf16 v18, v156, v156, v18
    v_dot2_f32_bf16 v17, v157, s76, v17
    v_dot2_f32_bf16 v19, v157, v157, v19
    v_dot2_f32_bf16 v16, v158, s76, v16
    v_dot2_f32_bf16 v18, v158, v158, v18
    v_dot2_f32_bf16 v17, v159, s76, v17
    v_dot2_f32_bf16 v19, v159, v159, v19
    s_barrier
    ds_read_b128 v[160:163], v100 offset:0
    ds_read_b128 v[164:167], v101 offset:0
    ds_read_b128 v[168:171], v102 offset:0
    ds_read_b128 v[172:175], v103 offset:0
    ds_read_b128 v[176:179], v100 offset:4096
    ds_read_b128 v[180:183], v101 offset:4096
    ds_read_b128 v[184:187], v102 offset:4096
    ds_read_b128 v[188:191], v103 offset:4096
    s_add_u32 m0, s70, 24576
    s_nop 0
    buffer_load_dwordx4 v68, s[16:19], s61 offen offset:0 lds
    buffer_load_dwordx4 v69, s[16:19], s61 offen offset:1024 lds
    buffer_load_dwordx4 v70, s[16:19], s61 offen offset:2048 lds
    buffer_load_dwordx4 v71, s[16:19], s61 offen offset:3072 lds
    s_cmp_lg_u32 s32, 1
    s_cbranch_scc1 K1b_t1
    s_mov_b64 exec, 0xffffffff
    buffer_load_dword v31, v77, s[16:19], s84 offen
    s_branch K1b_tx
K1b_t1:
    s_cmp_lg_u32 s32, 2
    s_cbranch_scc1 K1b_t2
    s_mov_b64 exec, 0xffffffff
    buffer_load_dword v31, v77, s[16:19], s85 offen
    s_branch K1b_tx
K1b_t2:
    s_cmp_lg_u32 s32, 3
    s_cbranch_scc1 K1b_t3
    s_mov_b64 exec, 0xffffffff
    buffer_load_dword v31, v77, s[16:19], s86 offen
    s_branch K1b_tx
K1b_t3:
K1b_tx:
    s_mov_b64 exec, -1
    s_waitcnt vmcnt(4)
    s_waitcnt lgkmcnt(0)
    s_barrier
    ds_read_b64_tr_b16 v[80:81], v6 offset:8192
    ds_read_b64_tr_b16 v[82:83], v6 offset:8704
    ds_read_b64_tr_b16 v[84:85], v6 offset:10240
    ds_read_b64_tr_b16 v[86:87], v6 offset:10752
    ds_read_b64_tr_b16 v[88:89], v6 offset:12288
    ds_read_b64_tr_b16 v[90:91], v6 offset:12800
    ds_read_b64_tr_b16 v[92:93], v6 offset:14336
    ds_read_b64_tr_b16 v[94:95], v6 offset:14848
    ds_read_b64_tr_b16 v[96:97], v7 offset:8192
    ds_read_b64_tr_b16 v[98:99], v7 offset:8704
    s_waitcnt lgkmcnt(6)
    v_mfma_f32_16x16x32_bf16 v[122:125], v[118:121], v[80:83], 0
    v_mfma_f32_32x32x16_bf16 v[32:47], v[128:131], v[80:83], 0
    s_add_u32 m0, s71, 0
    s_xor_b32 s77, s77, 512
    buffer_load_dwordx4 v106, s[4:7], s77 offen offset:0 lds
    s_lshl_b32 s94, s3, 7
    ds_read_b64_tr_b16 v[80:81], v7 offset:10240
    ds_read_b64_tr_b16 v[82:83], v7 offset:10752
    v_mfma_f32_16x16x32_bf16 v[122:125], v[118:121], v[84:87], v[122:125]
    v_mfma_f32_32x32x16_bf16 v[32:47], v[132:135], v[84:87], v[32:47]
    buffer_load_dwordx4 v107, s[4:7], s77 offen offset:1024 lds
    s_add_u32 s94, s94, s75
    s_lshl_b32 s72, s81, 8
    s_add_u32 s72, s72, s94
    ds_read_b64_tr_b16 v[84:85], v7 offset:12288
    ds_read_b64_tr_b16 v[86:87], v7 offset:12800
    s_waitcnt lgkmcnt(6)
    v_mfma_f32_16x16x32_bf16 v[122:125], v[118:121], v[88:91], v[122:125]
    v_mfma_f32_32x32x16_bf16 v[32:47], v[136:139], v[88:91], v[32:47]
    buffer_load_dwordx4 v108, s[4:7], s77 offen offset:2048 lds
    s_lshl_b32 s36, s72, 10
    s_add_u32 s37, s36, 0x10000
    s_cmp_lt_u32 s81, 8
    s_cselect_b32 s38, 0x3eb8aa3b, 1.0
    ds_read_b64_tr_b16 v[88:89], v7 offset:14336
    ds_read_b64_tr_b16 v[90:91], v7 offset:14848
    v_mfma_f32_16x16x32_bf16 v[122:125], v[118:121], v[92:95], v[122:125]
    v_mfma_f32_32x32x16_bf16 v[32:47], v[140:143], v[92:95], v[32:47]
    buffer_load_dwordx4 v109, s[4:7], s77 offen offset:3072 lds
    s_lshl_b32 s72, s34, 9
    s_add_u32 s72, s72, s94
    s_lshl_b32 s72, s72, 10
    ds_read_b64_tr_b16 v[92:93], v8 offset:8192
    ds_read_b64_tr_b16 v[94:95], v8 offset:8704
    s_waitcnt lgkmcnt(6)
    v_mfma_f32_32x32x16_bf16 v[32:47], v[144:147], v[96:99], v[32:47]
    s_add_u32 s39, s72, 0x400000
    s_add_u32 s40, s39, 262144
    s_mul_i32 s72, s75, 114688
    s_lshl_b32 s73, s34, 12
    s_add_u32 s72, s72, s73
    s_lshl_b32 s73, s3, 11
    s_add_u32 s72, s72, s73
    s_add_u32 s41, s72, 0x600000
    s_add_u32 s42, s72, 0x618000
    ds_read_b64_tr_b16 v[96:97], v8 offset:10240
    ds_read_b64_tr_b16 v[98:99], v8 offset:10752
    v_mfma_f32_32x32x16_bf16 v[32:47], v[148:151], v[80:83], v[32:47]
    s_add_u32 m0, s71, 4096
    s_xor_b32 s78, s78, 512
    buffer_load_dwordx4 v106, s[4:7], s78 offen offset:0 lds
    s_lshl_b32 s94, s3, 6
    ds_read_b64_tr_b16 v[80:81], v8 offset:12288
    ds_read_b64_tr_b16 v[82:83], v8 offset:12800
    s_waitcnt lgkmcnt(6)
    v_mfma_f32_32x32x16_bf16 v[32:47], v[152:155], v[84:87], v[32:47]
    buffer_load_dwordx4 v107, s[4:7], s78 offen offset:1024 lds
    s_add_u32 s94, s94, s75
    s_lshl_b32 s94, s94, 2
    s_add_u32 s94, s94, 0x1200000
    ds_read_b64_tr_b16 v[84:85], v8 offset:14336
    ds_read_b64_tr_b16 v[86:87], v8 offset:14848
    v_mfma_f32_32x32x16_bf16 v[32:47], v[156:159], v[88:91], v[32:47]
    buffer_load_dwordx4 v108, s[4:7], s78 offen offset:2048 lds
    s_lshl_b32 s72, s81, 9
    s_add_u32 s46, s94, s72
    s_lshl_b32 s72, s34, 10
    ds_read_b64_tr_b16 v[88:89], v9 offset:8192
    ds_read_b64_tr_b16 v[90:91], v9 offset:8704
    s_waitcnt lgkmcnt(6)
    v_mfma_f32_32x32x16_bf16 v[32:47], v[160:163], v[92:95], v[32:47]
    buffer_load_dwordx4 v109, s[4:7], s78 offen offset:3072 lds
    s_add_u32 s47, s94, s72
    s_add_u32 s47, s47, 8192
    s_lshl_b32 s72, s75, 4
    ds_read_b64_tr_b16 v[92:93], v9 offset:10240
    ds_read_b64_tr_b16 v[94:95], v9 offset:10752
    v_mfma_f32_32x32x16_bf16 v[32:47], v[164:167], v[96:99], v[32:47]
    s_add_u32 s72, s72, s34
    s_lshl_b32 s72, s72, 1
    s_add_u32 s72, s72, s3
    s_lshl_b32 s72, s72, 2
    s_add_u32 s48, s72, 0x1204060
    s_lshl_b32 s72, s2, 2
    s_add_u32 s72, s72, 0x1208000
    s_cmp_eq_u32 s32, 0
    s_cselect_b32 s49, s72, 0x40000000
    s_and_b32 s82, s2, 7
    ds_read_b64_tr_b16 v[96:97], v9 offset:12288
    ds_read_b64_tr_b16 v[98:99], v9 offset:12800
    s_waitcnt lgkmcnt(6)
    v_mfma_f32_32x32x16_bf16 v[32:47], v[168:171], v[80:83], v[32:47]
    s_add_u32 m0, s70, 0
    s_nop 0
    buffer_load_dwordx4 v68, s[16:19], s62 offen offset:0 lds
    s_lshl_b32 s82, s82, 2
    s_waitcnt vmcnt(9)
    s_barrier
    ds_read_b64_tr_b16 v[80:81], v9 offset:14336
    ds_read_b64_tr_b16 v[82:83], v9 offset:14848
    v_mfma_f32_32x32x16_bf16 v[32:47], v[172:175], v[84:87], v[32:47]
    buffer_load_dwordx4 v69, s[16:19], s62 offen offset:1024 lds
    s_lshr_b32 s72, s2, 6
    s_add_u32 s82, s82, s72
    s_bfe_u32 s83, s2, 0x30003
    ds_read_b64_tr_b16 v[84:85], v6 offset:24576
    ds_read_b64_tr_b16 v[86:87], v6 offset:25088
    s_waitcnt lgkmcnt(6)
    v_mfma_f32_32x32x16_bf16 v[32:47], v[176:179], v[88:91], v[32:47]
    buffer_load_dwordx4 v70, s[16:19], s62 offen offset:2048 lds
    s_lshl_b32 s83, s83, 3
    s_lshl_b32 s72, s35, 1
    s_add_u32 s83, s83, s72
    ds_read_b64_tr_b16 v[88:89], v6 offset:26624
    ds_read_b64_tr_b16 v[90:91], v6 offset:27136
    v_mfma_f32_32x32x16_bf16 v[32:47], v[180:183], v[92:95], v[32:47]
    buffer_load_dwordx4 v71, s[16:19], s62 offen offset:3072 lds
    s_add_u32 s72, s83, s3
    s_lshl_b32 s72, s72, 5
    s_add_u32 s72, s72, s82
    ds_read_b64_tr_b16 v[92:93], v6 offset:28672
    ds_read_b64_tr_b16 v[94:95], v6 offset:29184
    s_waitcnt lgkmcnt(6)
    v_mfma_f32_32x32x16_bf16 v[32:47], v[184:187], v[96:99], v[32:47]
    s_lshl_b32 s72, s72, 10
    s_add_u32 s56, s72, 0x1000000
    s_lshl_b32 s54, s82, 16
    s_lshl_b32 s72, s3, 12
    s_add_u32 s54, s54, s72
    s_lshr_b32 s72, s35, 1
    s_lshl_b32 s72, s72, 15
    s_add_u32 s54, s54, s72
    s_and_b32 s72, s35, 1
    ds_read_b64_tr_b16 v[96:97], v6 offset:30720
    ds_read_b64_tr_b16 v[98:99], v6 offset:31232
    v_mfma_f32_32x32x16_bf16 v[32:47], v[188:191], v[80:83], v[32:47]
    s_lshl_b32 s72, s72, 21
    s_add_u32 s54, s54, s72
    s_add_u32 s54, s54, 0x200000
    s_lshl_b32 s55, s82, 6
    s_add_u32 s55, s55, s83
    s_lshl_b32 s55, s55, 10
    s_lshr_b32 s72, s82, 1
    s_lshl_b32 s72, s72, 8
    s_add_u32 s72, s72, 0x1200000
    s_lshl_b32 s58, s83, 2
    ds_read_b64_tr_b16 v[80:81], v7 offset:24576
    ds_read_b64_tr_b16 v[82:83], v7 offset:25088
    s_waitcnt lgkmcnt(6)
    v_mfma_f32_16x16x32_bf16 v[64:67], v[118:121], v[84:87], 0
    v_mfma_f32_32x32x16_bf16 v[48:63], v[128:131], v[84:87], 0
    s_add_u32 s58, s58, s72
    s_and_b32 s57, s35, 1
    s_lshl_b32 s57, s57, 12
    s_add_u32 s57, s57, s72
    s_add_u32 s57, s57, 4096
    s_sub_u32 s57, s57, s58
    s_lshl_b32 s72, s3, 2
    s_lshl_b32 s72, 0x0f0f0f0f, s72
    ds_read_b64_tr_b16 v[84:85], v7 offset:26624
    ds_read_b64_tr_b16 v[86:87], v7 offset:27136
    v_mfma_f32_16x16x32_bf16 v[64:67], v[118:121], v[88:91], v[64:67]
    v_mfma_f32_32x32x16_bf16 v[48:63], v[132:135], v[88:91], v[48:63]
    s_waitcnt vmcnt(4)
    ds_read_b128 v[192:195], v24 offset:0
    ds_read_b128 v[196:199], v25 offset:0
    s_cmp_lt_u32 s35, 2
    s_cselect_b32 s52, s72, 0
    s_cselect_b32 s53, 0, s72
    s_getpc_b64 s[98:99]
K1b_pc2:
    s_add_u32 s98, s98, K2_start-K1b_pc2
    s_addc_u32 s99, s99, 0
    ds_read_b64_tr_b16 v[88:89], v7 offset:28672
    ds_read_b64_tr_b16 v[90:91], v7 offset:29184
    s_waitcnt lgkmcnt(8)
    v_mfma_f32_16x16x32_bf16 v[64:67], v[118:121], v[92:95], v[64:67]
    v_mfma_f32_32x32x16_bf16 v[48:63], v[136:139], v[92:95], v[48:63]
    ds_read_b128 v[200:203], v26 offset:0
    ds_read_b128 v[204:207], v27 offset:0
    ds_read_b128 v[208:211], v24 offset:4096
    v_lshlrev_b32 v30, 7, v0
    v_min_u32 v30, K2_fallback-K2_start, v30
    s_mov_b32 s94, 0x05040100
    s_mov_b32 s95, 0x07060302
    ds_read_b64_tr_b16 v[92:93], v7 offset:30720
    ds_read_b64_tr_b16 v[94:95], v7 offset:31232
    v_mfma_f32_16x16x32_bf16 v[64:67], v[118:121], v[96:99], v[64:67]
    v_mfma_f32_32x32x16_bf16 v[48:63], v[140:143], v[96:99], v[48:63]
    ds_read_b128 v[212:215], v25 offset:4096
    ds_read_b128 v[216:219], v26 offset:4096
    ds_read_b128 v[220:223], v27 offset:4096
    v_mov_b32 v112, -1
    v_mov_b32 v113, -1
    v_mov_b32 v114, -1
    v_mov_b32 v115, -1
    buffer_store_dwordx4 v[112:115], v10, s[20:23], s56 offen sc1
    s_barrier
    ds_read_b64_tr_b16 v[96:97], v8 offset:24576
    ds_read_b64_tr_b16 v[98:99], v8 offset:25088
    ds_read_b128 v[224:227], v100 offset:0
    ds_read_b128 v[228:231], v101 offset:0
    ds_read_b128 v[232:235], v102 offset:0
    ds_read_b128 v[236:239], v103 offset:0
    ds_read_b128 v[240:243], v100 offset:4096
    ds_read_b128 v[244:247], v101 offset:4096
    ds_read_b128 v[248:251], v102 offset:4096
    ds_read_b128 v[252:255], v103 offset:4096
    s_waitcnt lgkmcnt(15)
    v_dot2_f32_bf16 v16, v192, s76, v16
    v_dot2_f32_bf16 v18, v192, v192, v18
    s_add_u32 m0, s70, 8192
    s_nop 0
    v_dot2_f32_bf16 v17, v193, s76, v17
    v_dot2_f32_bf16 v19, v193, v193, v19
    v_dot2_f32_bf16 v16, v194, s76, v16
    v_dot2_f32_bf16 v18, v194, v194, v18
    v_dot2_f32_bf16 v17, v195, s76, v17
    v_dot2_f32_bf16 v19, v195, v195, v19
    buffer_load_dwordx4 v68, s[16:19], s63 offen offset:0 lds
    v_dot2_f32_bf16 v16, v196, s76, v16
    v_dot2_f32_bf16 v18, v196, v196, v18
    v_dot2_f32_bf16 v17, v197, s76, v17
    v_dot2_f32_bf16 v19, v197, v197, v19
    v_dot2_f32_bf16 v16, v198, s76, v16
    v_dot2_f32_bf16 v18, v198, v198, v18
    v_dot2_f32_bf16 v17, v199, s76, v17
    v_dot2_f32_bf16 v19, v199, v199, v19
    v_dot2_f32_bf16 v16, v200, s76, v16
    v_dot2_f32_bf16 v18, v200, v200, v18
    v_dot2_f32_bf16 v17, v201, s76, v17
    v_dot2_f32_bf16 v19, v201, v201, v19
    v_dot2_f32_bf16 v16, v202, s76, v16
    v_dot2_f32_bf16 v18, v202, v202, v18
    buffer_load_dwordx4 v69, s[16:19], s63 offen offset:1024 lds
    v_dot2_f32_bf16 v17, v203, s76, v17
    v_dot2_f32_bf16 v19, v203, v203, v19
    v_dot2_f32_bf16 v16, v204, s76, v16
    v_dot2_f32_bf16 v18, v204, v204, v18
    v_dot2_f32_bf16 v17, v205, s76, v17
    v_dot2_f32_bf16 v19, v205, v205, v19
    v_dot2_f32_bf16 v16, v206, s76, v16
    v_dot2_f32_bf16 v18, v206, v206, v18
    v_dot2_f32_bf16 v17, v207, s76, v17
    v_dot2_f32_bf16 v19, v207, v207, v19
    s_waitcnt lgkmcnt(10)
    v_dot2_f32_bf16 v16, v208, s76, v16
    v_dot2_f32_bf16 v18, v208, v208, v18
    buffer_load_dwordx4 v70, s[16:19], s63 offen offset:2048 lds
    v_dot2_f32_bf16 v17, v209, s76, v17
    v_dot2_f32_bf16 v19, v209, v209, v19
    v_dot2_f32_bf16 v16, v210, s76, v16
    v_dot2_f32_bf16 v18, v210, v210, v18
    v_dot2_f32_bf16 v17, v211, s76, v17
    v_dot2_f32_bf16 v19, v211, v211, v19
    v_dot2_f32_bf16 v16, v212, s76, v16
    v_dot2_f32_bf16 v18, v212, v212, v18
    v_dot2_f32_bf16 v17, v213, s76, v17
    v_dot2_f32_bf16 v19, v213, v213, v19
    v_dot2_f32_bf16 v16, v214, s76, v16
    v_dot2_f32_bf16 v18, v214, v214, v18
    v_dot2_f32_bf16 v17, v215, s76, v17
    v_dot2_f32_bf16 v19, v215, v215, v19
    buffer_load_dwordx4 v71, s[16:19], s63 offen offset:3072 lds
    v_dot2_f32_bf16 v16, v216, s76, v16
    v_dot2_f32_bf16 v18, v216, v216, v18
    v_dot2_f32_bf16 v17, v217, s76, v17
    v_dot2_f32_bf16 v19, v217, v217, v19
    v_dot2_f32_bf16 v16, v218, s76, v16
    v_dot2_f32_bf16 v18, v218, v218, v18
    v_dot2_f32_bf16 v17, v219, s76, v17
    v_dot2_f32_bf16 v19, v219, v219, v19
    v_dot2_f32_bf16 v16, v220, s76, v16
    v_dot2_f32_bf16 v18, v220, v220, v18
    v_dot2_f32_bf16 v17, v221, s76, v17
    v_dot2_f32_bf16 v19, v221, v221, v19
    v_dot2_f32_bf16 v16, v222, s76, v16
    v_dot2_f32_bf16 v18, v222, v222, v18
    s_cmp_lg_u32 s32, 2
    s_cbranch_scc1 K1b_u2
    s_mov_b64 exec, 0xffffffff
    buffer_load_dword v31, v76, s[8:11], s79 offen
    s_branch K1b_ux
K1b_u2:
    s_cmp_lg_u32 s32, 3
    s_cbranch_scc1 K1b_u3
    s_mov_b64 exec, 0xffffffff
    buffer_load_dword v31, v76, s[12:15], s80 offen
    s_branch K1b_ux
K1b_u3:
    s_cmp_lg_u32 s32, 0
    s_cbranch_scc1 K1b_u0
    global_load_dword v31, v30, s[98:99]
    s_branch K1b_ux
K1b_u0:
    s_cmp_lg_u32 s32, 1
    s_cbranch_scc1 K1b_u1
    s_mov_b64 exec, 0xffffffff
    global_load_dword v31, v30, s[98:99]
    s_branch K1b_ux
K1b_u1:
K1b_ux:
    s_mov_b64 exec, -1
    v_dot2_f32_bf16 v17, v223, s76, v17
    v_dot2_f32_bf16 v19, v223, v223, v19
    v_mfma_f32_32x32x16_bf16 v[48:63], v[144:147], v[80:83], v[48:63]
    ds_read_b64_tr_b16 v[80:81], v8 offset:26624
    ds_read_b64_tr_b16 v[82:83], v8 offset:27136
    v_mfma_f32_32x32x16_bf16 v[48:63], v[148:151], v[84:87], v[48:63]
    ds_read_b64_tr_b16 v[84:85], v8 offset:28672
    ds_read_b64_tr_b16 v[86:87], v8 offset:29184
    v_mfma_f32_32x32x16_bf16 v[48:63], v[152:155], v[88:91], v[48:63]
    ds_read_b64_tr_b16 v[88:89], v8 offset:30720
    ds_read_b64_tr_b16 v[90:91], v8 offset:31232
    v_mfma_f32_32x32x16_bf16 v[48:63], v[156:159], v[92:95], v[48:63]
    ds_read_b64_tr_b16 v[92:93], v9 offset:24576
    ds_read_b64_tr_b16 v[94:95], v9 offset:25088
    s_waitcnt lgkmcnt(6)
    v_mfma_f32_32x32x16_bf16 v[48:63], v[160:163], v[96:99], v[48:63]
    ds_read_b64_tr_b16 v[96:97], v9 offset:26624
    ds_read_b64_tr_b16 v[98:99], v9 offset:27136
    v_mfma_f32_32x32x16_bf16 v[48:63], v[164:167], v[80:83], v[48:63]
    ds_read_b64_tr_b16 v[80:81], v9 offset:28672
    ds_read_b64_tr_b16 v[82:83], v9 offset:29184
    s_waitcnt lgkmcnt(6)
    v_mfma_f32_32x32x16_bf16 v[48:63], v[168:171], v[84:87], v[48:63]
    s_waitcnt vmcnt(5)
    s_barrier
    ds_read_b64_tr_b16 v[84:85], v9 offset:30720
    ds_read_b64_tr_b16 v[86:87], v9 offset:31232
    v_mfma_f32_32x32x16_bf16 v[48:63], v[172:175], v[88:91], v[48:63]
    v_add_f32 v16, v16, v17
    v_add_f32 v18, v18, v19
    ds_read_b64_tr_b16 v[88:89], v6 offset:0
    ds_read_b64_tr_b16 v[90:91], v6 offset:512
    s_waitcnt lgkmcnt(6)
    v_mfma_f32_32x32x16_bf16 v[48:63], v[176:179], v[92:95], v[48:63]
    s_add_u32 m0, s70, 16384
    s_nop 0
    buffer_load_dwordx4 v68, s[16:19], s64 offen offset:0 lds
    ds_read_b64_tr_b16 v[92:93], v6 offset:2048
    ds_read_b64_tr_b16 v[94:95], v6 offset:2560
    v_mfma_f32_32x32x16_bf16 v[48:63], v[180:183], v[96:99], v[48:63]
    v_mov_b32 v20, v16
    v_mov_b32 v19, v18
    ds_read_b64_tr_b16 v[96:97], v6 offset:4096
    ds_read_b64_tr_b16 v[98:99], v6 offset:4608
    s_waitcnt lgkmcnt(6)
    v_mfma_f32_32x32x16_bf16 v[48:63], v[184:187], v[80:83], v[48:63]
    v_permlane32_swap_b32 v16, v20
    v_permlane32_swap_b32 v18, v19
    ds_read_b64_tr_b16 v[80:81], v6 offset:6144
    ds_read_b64_tr_b16 v[82:83], v6 offset:6656
    v_mfma_f32_32x32x16_bf16 v[48:63], v[188:191], v[84:87], v[48:63]
    buffer_load_dwordx4 v69, s[16:19], s64 offen offset:1024 lds
    ds_read_b64_tr_b16 v[84:85], v7 offset:0
    ds_read_b64_tr_b16 v[86:87], v7 offset:512
    s_waitcnt lgkmcnt(6)
    v_mfma_f32_16x16x32_bf16 v[122:125], v[118:121], v[88:91], v[122:125]
    v_mfma_f32_32x32x16_bf16 v[32:47], v[192:195], v[88:91], v[32:47]
    v_add_f32 v16, v16, v20
    v_add_f32 v17, v18, v19
    ds_write_b64 v104, v[16:17]
    ds_read_b64_tr_b16 v[88:89], v7 offset:2048
    ds_read_b64_tr_b16 v[90:91], v7 offset:2560
    v_mfma_f32_16x16x32_bf16 v[122:125], v[118:121], v[92:95], v[122:125]
    v_mfma_f32_32x32x16_bf16 v[32:47], v[196:199], v[92:95], v[32:47]
    v_mov_b32 v26, 0
    v_mov_b32 v27, 0
    ds_read_b64_tr_b16 v[92:93], v7 offset:4096
    ds_read_b64_tr_b16 v[94:95], v7 offset:4608
    s_waitcnt lgkmcnt(7)
    v_mfma_f32_16x16x32_bf16 v[122:125], v[118:121], v[96:99], v[122:125]
    v_mfma_f32_32x32x16_bf16 v[32:47], v[200:203], v[96:99], v[32:47]
    ds_read_b64_tr_b16 v[96:97], v7 offset:6144
    ds_read_b64_tr_b16 v[98:99], v7 offset:6656
    v_mfma_f32_16x16x32_bf16 v[122:125], v[118:121], v[80:83], v[122:125]
    v_mfma_f32_32x32x16_bf16 v[32:47], v[204:207], v[80:83], v[32:47]
    buffer_load_dwordx4 v70, s[16:19], s64 offen offset:2048 lds
    ds_read_b64_tr_b16 v[80:81], v8 offset:0
    ds_read_b64_tr_b16 v[82:83], v8 offset:512
    s_waitcnt lgkmcnt(6)
    v_mfma_f32_32x32x16_bf16 v[32:47], v[208:211], v[84:87], v[32:47]
    ds_read_b64_tr_b16 v[84:85], v8 offset:2048
    ds_read_b64_tr_b16 v[86:87], v8 offset:2560
    v_mfma_f32_32x32x16_bf16 v[32:47], v[212:215], v[88:91], v[32:47]
    ds_read_b64_tr_b16 v[88:89], v8 offset:4096
    ds_read_b64_tr_b16 v[90:91], v8 offset:4608
    s_waitcnt lgkmcnt(6)
    v_mfma_f32_32x32x16_bf16 v[32:47], v[216:219], v[92:95], v[32:47]
    buffer_load_dwordx4 v71, s[16:19], s64 offen offset:3072 lds
    ds_read_b64_tr_b16 v[92:93], v8 offset:6144
    ds_read_b64_tr_b16 v[94:95], v8 offset:6656
    v_mfma_f32_32x32x16_bf16 v[32:47], v[220:223], v[96:99], v[32:47]
    ds_write_b32 v126, v122 offset:0
    ds_read_b64_tr_b16 v[96:97], v9 offset:0
    ds_read_b64_tr_b16 v[98:99], v9 offset:512
    s_waitcnt lgkmcnt(7)
    v_mfma_f32_32x32x16_bf16 v[32:47], v[224:227], v[80:83], v[32:47]
    ds_read_b64_tr_b16 v[80:81], v9 offset:2048
    ds_read_b64_tr_b16 v[82:83], v9 offset:2560
    v_mfma_f32_32x32x16_bf16 v[32:47], v[228:231], v[84:87], v[32:47]
    ds_read_b64_tr_b16 v[84:85], v9 offset:4096
    ds_read_b64_tr_b16 v[86:87], v9 offset:4608
    s_waitcnt lgkmcnt(7)
    v_mfma_f32_32x32x16_bf16 v[32:47], v[232:235], v[88:91], v[32:47]
    s_waitcnt vmcnt(4)
    s_waitcnt lgkmcnt(6)
    s_barrier
    ds_read_b64_tr_b16 v[88:89], v9 offset:6144
    ds_read_b64_tr_b16 v[90:91], v9 offset:6656
    v_mfma_f32_32x32x16_bf16 v[32:47], v[236:239], v[92:95], v[32:47]
    ds_read_b64 v[18:19], v105
    ds_read_b128 v[122:125], v28 offset:0
    ds_read_b64_tr_b16 v[92:93], v6 offset:8192
    ds_read_b64_tr_b16 v[94:95], v6 offset:8704
    s_waitcnt lgkmcnt(8)
    v_mfma_f32_32x32x16_bf16 v[32:47], v[240:243], v[96:99], v[32:47]
    s_add_u32 m0, s70, 24576
    s_nop 0
    buffer_load_dwordx4 v68, s[16:19], s65 offen offset:0 lds
    ds_read_b64_tr_b16 v[96:97], v6 offset:10240
    ds_read_b64_tr_b16 v[98:99], v6 offset:10752
    v_mfma_f32_32x32x16_bf16 v[32:47], v[244:247], v[80:83], v[32:47]
    s_waitcnt lgkmcnt(4)
    v_add_f32 v122, v122, v123
    v_add_f32 v124, v124, v125
    v_add_f32 v122, v122, v124
    v_cmp_gt_u32 vcc, 32, v1
    ds_read_b64_tr_b16 v[80:81], v6 offset:12288
    ds_read_b64_tr_b16 v[82:83], v6 offset:12800
    v_mfma_f32_32x32x16_bf16 v[32:47], v[248:251], v[84:87], v[32:47]
    v_cvt_pk_bf16_f32 v117, v122, v122
    v_and_b32 v123, 0xffff0000, v117
    v_sub_f32 v123, v122, v123
    v_cvt_pk_bf16_f32 v116, v122, v123
    v_add_f32 v16, v16, v18
    v_mul_f32 v16, 0xbb000000, v16
    ds_read_b64_tr_b16 v[84:85], v6 offset:14336
    ds_read_b64_tr_b16 v[86:87], v6 offset:14848
    v_mfma_f32_32x32x16_bf16 v[32:47], v[252:255], v[88:91], v[32:47]
    buffer_load_dwordx4 v69, s[16:19], s65 offen offset:1024 lds
    v_add_f32 v17, v17, v19
    v_cvt_pk_bf16_f32 v18, v16, v16
    ds_read_b64_tr_b16 v[88:89], v7 offset:8192
    ds_read_b64_tr_b16 v[90:91], v7 offset:8704
    s_waitcnt lgkmcnt(6)
    v_mfma_f32_16x16x32_bf16 v[64:67], v[118:121], v[92:95], v[64:67]
    v_mfma_f32_32x32x16_bf16 v[48:63], v[192:195], v[92:95], v[48:63]
    v_mul_f32 v17, 0x3b000000, v17
    v_and_b32 v19, 0xffff0000, v18
    v_fma_f32 v17, -v16, v16, v17
    v_sub_f32 v19, v16, v19
    v_max_f32 v17, 0, v17
    v_cvt_pk_bf16_f32 v19, v19, 0
    ds_read_b64_tr_b16 v[92:93], v7 offset:10240
    ds_read_b64_tr_b16 v[94:95], v7 offset:10752
    v_mfma_f32_16x16x32_bf16 v[64:67], v[118:121], v[96:99], v[64:67]
    v_mfma_f32_32x32x16_bf16 v[48:63], v[196:199], v[96:99], v[48:63]
    v_add_f32 v14, 0x3727c5ac, v17
    v_cndmask_b32 v24, 0, v18, vcc
    v_rsq_f32 v15, v14
    v_cndmask_b32 v25, 0, v19, vcc
    ds_read_b64_tr_b16 v[96:97], v7 offset:12288
    ds_read_b64_tr_b16 v[98:99], v7 offset:12800
    s_waitcnt lgkmcnt(6)
    v_mfma_f32_16x16x32_bf16 v[64:67], v[118:121], v[80:83], v[64:67]
    v_mfma_f32_32x32x16_bf16 v[48:63], v[200:203], v[80:83], v[48:63]
    v_mfma_f32_32x32x16_bf16 v[32:47], v[24:27], v[116:119], v[32:47]
    v_mul_f32 v12, 0xc0135761, v15
    v_mul_f32 v13, v15, v15
    v_mul_f32 v22, s38, v15
    v_mul_f32 v13, v13, v12
    v_mul_f32 v13, 0x3d372713, v13
    ds_read_b64_tr_b16 v[80:81], v7 offset:14336
    ds_read_b64_tr_b16 v[82:83], v7 offset:14848
    v_mfma_f32_16x16x32_bf16 v[64:67], v[118:121], v[84:87], v[64:67]
    v_mfma_f32_32x32x16_bf16 v[48:63], v[204:207], v[84:87], v[48:63]
    buffer_load_dwordx4 v70, s[16:19], s65 offen offset:2048 lds
    v_lshlrev_b32 v17, 2, v1
    v_sub_u32 v18, v104, v17
    ds_read_b64_tr_b16 v[84:85], v8 offset:8192
    ds_read_b64_tr_b16 v[86:87], v8 offset:8704
    s_waitcnt lgkmcnt(6)
    v_mfma_f32_32x32x16_bf16 v[48:63], v[208:211], v[88:91], v[48:63]
    ds_write_b32 v18, v15 offset:1024
    v_lshrrev_b32 v16, 5, v1
    v_lshlrev_b32 v16, 4, v16
    v_sub_u32 v18, v18, v17
    v_add_u32 v18, v18, v16
    ds_read_b64_tr_b16 v[88:89], v8 offset:10240
    ds_read_b64_tr_b16 v[90:91], v8 offset:10752
    v_mfma_f32_32x32x16_bf16 v[48:63], v[212:215], v[92:95], v[48:63]
    ds_read_b128 v[100:103], v18 offset:1024
    ds_read_b128 v[104:107], v18 offset:1056
    ds_read_b128 v[108:111], v18 offset:1088
    ds_read_b128 v[112:115], v18 offset:1120
    v_bfe_u32 v17, v1, 4, 1
    v_lshlrev_b32 v30, 16, v17
    v_lshl_add_u32 v30, v16, 4, v30
    ds_read_b64_tr_b16 v[92:93], v8 offset:12288
    ds_read_b64_tr_b16 v[94:95], v8 offset:12800
    s_waitcnt lgkmcnt(11)
    v_mfma_f32_32x32x16_bf16 v[48:63], v[216:219], v[96:99], v[48:63]
    buffer_load_dwordx4 v71, s[16:19], s65 offen offset:3072 lds
    v_and_b32 v17, 15, v1
    v_lshl_add_u32 v30, v17, 4, v30
    ds_read_b64_tr_b16 v[96:97], v8 offset:14336
    ds_read_b64_tr_b16 v[98:99], v8 offset:14848
    v_mfma_f32_32x32x16_bf16 v[48:63], v[220:223], v[80:83], v[48:63]
    ds_write_b32 v126, v64 offset:512
    ds_read_b64_tr_b16 v[80:81], v9 offset:8192
    ds_read_b64_tr_b16 v[82:83], v9 offset:8704
    s_waitcnt lgkmcnt(11)
    v_mfma_f32_32x32x16_bf16 v[48:63], v[224:227], v[84:87], v[48:63]
    ds_read_b64_tr_b16 v[84:85], v9 offset:10240
    ds_read_b64_tr_b16 v[86:87], v9 offset:10752
    v_mfma_f32_32x32x16_bf16 v[48:63], v[228:231], v[88:91], v[48:63]
    s_waitcnt lgkmcnt(9)
    v_mul_f32 v32, v32, v100
    v_mul_f32 v33, v33, v101
    v_cvt_pk_bf16_f32 v32, v32, v33
    v_mul_f32 v34, v34, v102
    ds_read_b64_tr_b16 v[88:89], v9 offset:12288
    ds_read_b64_tr_b16 v[90:91], v9 offset:12800
    s_waitcnt lgkmcnt(7)
    v_mfma_f32_32x32x16_bf16 v[48:63], v[232:235], v[92:95], v[48:63]
    v_mul_f32 v35, v35, v103
    v_cvt_pk_bf16_f32 v33, v34, v35
    v_mul_f32 v36, v36, v104
    v_mul_f32 v37, v37, v105
    s_waitcnt vmcnt(4)
    s_waitcnt lgkmcnt(6)
    s_barrier
    ds_read_b64_tr_b16 v[92:93], v9 offset:14336
    ds_read_b64_tr_b16 v[94:95], v9 offset:14848
    v_mfma_f32_32x32x16_bf16 v[48:63], v[236:239], v[96:99], v[48:63]
    ds_read_b128 v[16:19], v28 offset:512
    v_cvt_pk_bf16_f32 v34, v36, v37
    v_mul_f32 v38, v38, v106
    v_mul_f32 v39, v39, v107
    v_cvt_pk_bf16_f32 v35, v38, v39
    ds_read_b64_tr_b16 v[96:97], v6 offset:16384
    ds_read_b64_tr_b16 v[98:99], v6 offset:16896
    s_waitcnt lgkmcnt(7)
    v_mfma_f32_32x32x16_bf16 v[48:63], v[240:243], v[80:83], v[48:63]
    s_add_u32 m0, s70, 0
    s_nop 0
    buffer_load_dwordx4 v2, s[8:11], s66 offen offset:0 lds
    ds_read_b64_tr_b16 v[80:81], v6 offset:18432
    ds_read_b64_tr_b16 v[82:83], v6 offset:18944
    v_mfma_f32_32x32x16_bf16 v[48:63], v[244:247], v[84:87], v[48:63]
    s_waitcnt lgkmcnt(4)
    v_add_f32 v16, v16, v17
    v_add_f32 v18, v18, v19
    v_add_f32 v16, v16, v18
    buffer_store_dwordx4 v[32:35], v30, s[20:23], s39 offen offset:0 sc1
    ds_read_b64_tr_b16 v[84:85], v6 offset:20480
    ds_read_b64_tr_b16 v[86:87], v6 offset:20992
    v_mfma_f32_32x32x16_bf16 v[48:63], v[248:251], v[88:91], v[48:63]
    v_cvt_pk_bf16_f32 v117, v16, v16
    v_and_b32 v17, 0xffff0000, v117
    v_sub_f32 v17, v16, v17
    v_cvt_pk_bf16_f32 v116, v16, v17
    ds_read_b64_tr_b16 v[88:89], v6 offset:22528
    ds_read_b64_tr_b16 v[90:91], v6 offset:23040
    v_mfma_f32_32x32x16_bf16 v[48:63], v[252:255], v[92:95], v[48:63]
    buffer_load_dwordx4 v3, s[8:11], s66 offen offset:1024 lds
    v_mfma_f32_32x32x16_bf16 v[48:63], v[24:27], v[116:119], v[48:63]
    ds_read_b64_tr_b16 v[92:93], v7 offset:16384
    ds_read_b64_tr_b16 v[94:95], v7 offset:16896
    s_waitcnt lgkmcnt(6)
    v_mfma_f32_16x16x32_bf16 v[122:125], v[118:121], v[96:99], 0
    v_mfma_f32_32x32x16_bf16 v[64:79], v[96:99], v[128:131], 0
    v_mul_f32 v40, v40, v108
    v_mul_f32 v41, v41, v109
    v_cvt_pk_bf16_f32 v40, v40, v41
    v_mul_f32 v42, v42, v110
    v_mul_f32 v43, v43, v111
    ds_read_b64_tr_b16 v[96:97], v7 offset:18432
    ds_read_b64_tr_b16 v[98:99], v7 offset:18944
    v_mfma_f32_16x16x32_bf16 v[122:125], v[118:121], v[80:83], v[122:125]
    v_mfma_f32_32x32x16_bf16 v[64:79], v[80:83], v[132:135], v[64:79]
    v_cvt_pk_bf16_f32 v41, v42, v43
    v_mul_f32 v44, v44, v112
    v_mul_f32 v45, v45, v113
    v_cvt_pk_bf16_f32 v42, v44, v45
    ds_read_b64_tr_b16 v[80:81], v7 offset:20480
    ds_read_b64_tr_b16 v[82:83], v7 offset:20992
    s_waitcnt lgkmcnt(6)
    v_mfma_f32_16x16x32_bf16 v[122:125], v[118:121], v[84:87], v[122:125]
    v_mfma_f32_32x32x16_bf16 v[64:79], v[84:87], v[136:139], v[64:79]
    v_mul_f32 v46, v46, v114
    v_mul_f32 v47, v47, v115
    v_cvt_pk_bf16_f32 v43, v46, v47
    buffer_store_dwordx4 v[40:43], v30, s[20:23], s39 offen offset:512 sc1
    ds_read_b64_tr_b16 v[84:85], v7 offset:22528
    ds_read_b64_tr_b16 v[86:87], v7 offset:23040
    v_mfma_f32_16x16x32_bf16 v[122:125], v[118:121], v[88:91], v[122:125]
    v_mfma_f32_32x32x16_bf16 v[64:79], v[88:91], v[140:143], v[64:79]
    buffer_load_dwordx4 v4, s[8:11], s66 offen offset:2048 lds
    ds_read_b64_tr_b16 v[88:89], v8 offset:16384
    ds_read_b64_tr_b16 v[90:91], v8 offset:16896
    s_waitcnt lgkmcnt(6)
    v_mfma_f32_32x32x16_bf16 v[64:79], v[92:95], v[144:147], v[64:79]
    ds_read_b64_tr_b16 v[92:93], v8 offset:18432
    ds_read_b64_tr_b16 v[94:95], v8 offset:18944
    v_mfma_f32_32x32x16_bf16 v[64:79], v[96:99], v[148:151], v[64:79]
    ds_read_b64_tr_b16 v[96:97], v8 offset:20480
    ds_read_b64_tr_b16 v[98:99], v8 offset:20992
    s_waitcnt lgkmcnt(6)
    v_mfma_f32_32x32x16_bf16 v[64:79], v[80:83], v[152:155], v[64:79]
    buffer_load_dwordx4 v5, s[8:11], s66 offen offset:3072 lds
    v_mul_f32 v48, v48, v100
    ds_read_b64_tr_b16 v[80:81], v8 offset:22528
    ds_read_b64_tr_b16 v[82:83], v8 offset:23040
    v_mfma_f32_32x32x16_bf16 v[64:79], v[84:87], v[156:159], v[64:79]
    v_mul_f32 v49, v49, v101
    v_cvt_pk_bf16_f32 v48, v48, v49
    v_mul_f32 v50, v50, v102
    v_mul_f32 v51, v51, v103
    v_cvt_pk_bf16_f32 v49, v50, v51
    ds_read_b64_tr_b16 v[84:85], v9 offset:16384
    ds_read_b64_tr_b16 v[86:87], v9 offset:16896
    s_waitcnt lgkmcnt(6)
    v_mfma_f32_32x32x16_bf16 v[64:79], v[88:91], v[160:163], v[64:79]
    v_mul_f32 v52, v52, v104
    v_mul_f32 v53, v53, v105
    v_cvt_pk_bf16_f32 v50, v52, v53
    v_mul_f32 v54, v54, v106
    v_mul_f32 v55, v55, v107
    ds_read_b64_tr_b16 v[88:89], v9 offset:18432
    ds_read_b64_tr_b16 v[90:91], v9 offset:18944
    v_mfma_f32_32x32x16_bf16 v[64:79], v[92:95], v[164:167], v[64:79]
    v_cvt_pk_bf16_f32 v51, v54, v55
    buffer_store_dwordx4 v[48:51], v30, s[20:23], s40 offen offset:0 sc1
    v_mul_f32 v56, v56, v108
    ds_read_b64_tr_b16 v[92:93], v9 offset:20480
    ds_read_b64_tr_b16 v[94:95], v9 offset:20992
    s_waitcnt lgkmcnt(6)
    v_mfma_f32_32x32x16_bf16 v[64:79], v[96:99], v[168:171], v[64:79]
    buffer_load_dword v31, v26, s[28:31], 0 offen
    v_mul_f32 v57, v57, v109
    v_cvt_pk_bf16_f32 v56, v56, v57
    s_waitcnt vmcnt(8)
    s_barrier
    ds_read_b64_tr_b16 v[96:97], v9 offset:22528
    ds_read_b64_tr_b16 v[98:99], v9 offset:23040
    v_mfma_f32_32x32x16_bf16 v[64:79], v[80:83], v[172:175], v[64:79]
    v_mul_f32 v58, v58, v110
    v_mul_f32 v59, v59, v111
    v_cvt_pk_bf16_f32 v57, v58, v59
    v_mul_f32 v60, v60, v112
    v_mul_f32 v61, v61, v113
    ds_read_b64_tr_b16 v[80:81], v6 offset:24576
    ds_read_b64_tr_b16 v[82:83], v6 offset:25088
    s_waitcnt lgkmcnt(6)
    v_mfma_f32_32x32x16_bf16 v[64:79], v[84:87], v[176:179], v[64:79]
    s_add_u32 m0, s70, 8192
    s_nop 0
    buffer_load_dwordx4 v2, s[8:11], s67 offen offset:0 lds
    v_cvt_pk_bf16_f32 v58, v60, v61
    ds_read_b64_tr_b16 v[84:85], v6 offset:26624
    ds_read_b64_tr_b16 v[86:87], v6 offset:27136
    v_mfma_f32_32x32x16_bf16 v[64:79], v[88:91], v[180:183], v[64:79]
    buffer_load_dwordx4 v3, s[8:11], s67 offen offset:1024 lds
    v_mul_f32 v62, v62, v114
    v_mul_f32 v63, v63, v115
    ds_read_b64_tr_b16 v[88:89], v6 offset:28672
    ds_read_b64_tr_b16 v[90:91], v6 offset:29184
    s_waitcnt lgkmcnt(6)
    v_mfma_f32_32x32x16_bf16 v[64:79], v[92:95], v[184:187], v[64:79]
    buffer_load_dwordx4 v4, s[8:11], s67 offen offset:2048 lds
    v_cvt_pk_bf16_f32 v59, v62, v63
    ds_read_b64_tr_b16 v[92:93], v6 offset:30720
    ds_read_b64_tr_b16 v[94:95], v6 offset:31232
    v_mfma_f32_32x32x16_bf16 v[64:79], v[96:99], v[188:191], v[64:79]
    buffer_load_dwordx4 v5, s[8:11], s67 offen offset:3072 lds
    buffer_store_dwordx4 v[56:59], v30, s[20:23], s40 offen offset:512 sc1
    ds_read_b64_tr_b16 v[96:97], v7 offset:24576
    ds_read_b64_tr_b16 v[98:99], v7 offset:25088
    s_waitcnt lgkmcnt(6)
    v_mfma_f32_16x16x32_bf16 v[122:125], v[118:121], v[80:83], v[122:125]
    v_mfma_f32_32x32x16_bf16 v[64:79], v[80:83], v[192:195], v[64:79]
    v_lshlrev_b32 v108, 2, v1
    ds_read_b64_tr_b16 v[80:81], v7 offset:26624
    ds_read_b64_tr_b16 v[82:83], v7 offset:27136
    v_mfma_f32_16x16x32_bf16 v[122:125], v[118:121], v[84:87], v[122:125]
    v_mfma_f32_32x32x16_bf16 v[64:79], v[84:87], v[196:199], v[64:79]
    v_and_b32 v110, 4, v108
    ds_read_b64_tr_b16 v[84:85], v7 offset:28672
    ds_read_b64_tr_b16 v[86:87], v7 offset:29184
    s_waitcnt lgkmcnt(6)
    v_mfma_f32_16x16x32_bf16 v[122:125], v[118:121], v[88:91], v[122:125]
    v_mfma_f32_32x32x16_bf16 v[64:79], v[88:91], v[200:203], v[64:79]
    v_add_u32 v109, s57, v108
    ds_read_b64_tr_b16 v[88:89], v7 offset:30720
    ds_read_b64_tr_b16 v[90:91], v7 offset:31232
    v_mfma_f32_16x16x32_bf16 v[122:125], v[118:121], v[92:95], v[122:125]
    v_mfma_f32_32x32x16_bf16 v[64:79], v[92:95], v[204:207], v[64:79]
    v_cndmask_b32 v108, v110, v109, s[52:53]
    ds_read_b64_tr_b16 v[92:93], v8 offset:24576
    ds_read_b64_tr_b16 v[94:95], v8 offset:25088
    s_waitcnt lgkmcnt(6)
    v_mfma_f32_32x32x16_bf16 v[64:79], v[96:99], v[208:211], v[64:79]
    v_and_b32 v112, 22, v0
    ds_read_b64_tr_b16 v[96:97], v8 offset:26624
    ds_read_b64_tr_b16 v[98:99], v8 offset:27136
    v_mfma_f32_32x32x16_bf16 v[64:79], v[80:83], v[212:215], v[64:79]
    ds_read_b64_tr_b16 v[80:81], v8 offset:28672
    ds_read_b64_tr_b16 v[82:83], v8 offset:29184
    s_waitcnt lgkmcnt(6)
    v_mfma_f32_32x32x16_bf16 v[64:79], v[84:87], v[216:219], v[64:79]
    ds_read_b64_tr_b16 v[84:85], v8 offset:30720
    ds_read_b64_tr_b16 v[86:87], v8 offset:31232
    v_mfma_f32_32x32x16_bf16 v[64:79], v[88:91], v[220:223], v[64:79]
    ds_write_b32 v126, v122 offset:0
    ds_read_b64_tr_b16 v[88:89], v9 offset:24576
    ds_read_b64_tr_b16 v[90:91], v9 offset:25088
    s_waitcnt lgkmcnt(7)
    v_mfma_f32_32x32x16_bf16 v[64:79], v[92:95], v[224:227], v[64:79]
    v_cmp_eq_u32 vcc, 0, v112
    v_mov_b32 v113, s76
    v_lshlrev_b32 v112, 3, v0
    v_cndmask_b32 v114, 0, v113, vcc
    v_cndmask_b32 v115, 0, v113, vcc
    ds_read_b64_tr_b16 v[92:93], v9 offset:26624
    ds_read_b64_tr_b16 v[94:95], v9 offset:27136
    v_mfma_f32_32x32x16_bf16 v[64:79], v[96:99], v[228:231], v[64:79]
    ds_read_b64_tr_b16 v[96:97], v9 offset:28672
    ds_read_b64_tr_b16 v[98:99], v9 offset:29184
    s_waitcnt lgkmcnt(7)
    v_mfma_f32_32x32x16_bf16 v[64:79], v[80:83], v[232:235], v[64:79]
    s_waitcnt vmcnt(7)
    s_waitcnt lgkmcnt(6)
    s_barrier
    ds_read_b64_tr_b16 v[80:81], v9 offset:30720
    ds_read_b64_tr_b16 v[82:83], v9 offset:31232
    v_mfma_f32_32x32x16_bf16 v[64:79], v[84:87], v[236:239], v[64:79]
    ds_read_b128 v[16:19], v28 offset:0
    ds_write_b64 v112, v[114:115] offset:36864
    ds_read_b64_tr_b16 v[84:85], v6 offset:0
    ds_read_b64_tr_b16 v[86:87], v6 offset:512
    s_waitcnt lgkmcnt(8)
    v_mfma_f32_32x32x16_bf16 v[64:79], v[88:91], v[240:243], v[64:79]
    ds_write_b64 v112, v[114:115] offset:35840
    ds_write_b32 v26, v26 offset:34816
    s_waitcnt vmcnt(5)
    v_cmp_eq_u32 vcc, 0, v31
    s_nop 4
    s_cbranch_vccz K1b_nn1
    s_mov_b32 s74, 262144
K1b_nn0:
    buffer_load_dword v31, v26, s[28:31], 0 offen sc1
    s_waitcnt vmcnt(0)
    v_cmp_eq_u32 vcc, 0, v31
    s_nop 4
    s_cbranch_vccz K1b_nn1
    s_sub_u32 s74, s74, 1
    s_cbranch_scc0 K1b_nn0
K1b_nn1:
    v_readfirstlane_b32 s59, v31
    s_waitcnt vmcnt(0)
    s_mov_b64 exec, 1
    buffer_store_dword v31, v10, s[20:23], s47 offen offset:0 sc1
    buffer_store_dword v31, v10, s[20:23], s47 offen offset:512 sc1
    s_mov_b64 exec, -1
    ds_read_b64_tr_b16 v[88:89], v6 offset:2048
    ds_read_b64_tr_b16 v[90:91], v6 offset:2560
    v_mfma_f32_32x32x16_bf16 v[64:79], v[92:95], v[244:247], v[64:79]
    s_waitcnt lgkmcnt(7)
    v_add_f32 v16, v16, v17
    v_add_f32 v18, v18, v19
    v_add_f32 v16, v16, v18
    v_cvt_pk_bf16_f32 v117, v16, v16
    v_and_b32 v17, 0xffff0000, v117
    ds_read_b64_tr_b16 v[92:93], v6 offset:4096
    ds_read_b64_tr_b16 v[94:95], v6 offset:4608
    v_mfma_f32_32x32x16_bf16 v[64:79], v[96:99], v[248:251], v[64:79]
    s_add_u32 m0, s70, 16384
    s_nop 0
    buffer_load_dwordx4 v2, s[12:15], s68 offen offset:0 lds
    v_sub_f32 v17, v16, v17
    v_cvt_pk_bf16_f32 v116, v16, v17
    ds_read_b64_tr_b16 v[96:97], v6 offset:6144
    ds_read_b64_tr_b16 v[98:99], v6 offset:6656
    v_mfma_f32_32x32x16_bf16 v[64:79], v[80:83], v[252:255], v[64:79]
    buffer_load_dwordx4 v3, s[12:15], s68 offen offset:1024 lds
    v_mfma_f32_32x32x16_bf16 v[64:79], v[116:119], v[24:27], v[64:79]
    ds_read_b64_tr_b16 v[80:81], v7 offset:0
    ds_read_b64_tr_b16 v[82:83], v7 offset:512
    s_waitcnt lgkmcnt(6)
    v_mfma_f32_16x16x32_bf16 v[122:125], v[118:121], v[84:87], 0
    v_mfma_f32_32x32x16_bf16 v[32:47], v[84:87], v[128:131], 0
    buffer_load_dwordx4 v4, s[12:15], s68 offen offset:2048 lds
    ds_read_b64_tr_b16 v[84:85], v7 offset:2048
    ds_read_b64_tr_b16 v[86:87], v7 offset:2560
    v_mfma_f32_16x16x32_bf16 v[122:125], v[118:121], v[88:91], v[122:125]
    v_mfma_f32_32x32x16_bf16 v[32:47], v[88:91], v[132:135], v[32:47]
    buffer_load_dwordx4 v5, s[12:15], s68 offen offset:3072 lds
    s_nop 0
    v_mul_f32 v64, v64, v22
    v_mul_f32 v65, v65, v22
    v_cvt_pk_bf16_f32 v64, v64, v65
    v_mul_f32 v66, v66, v22
    ds_read_b64_tr_b16 v[88:89], v7 offset:4096
    ds_read_b64_tr_b16 v[90:91], v7 offset:4608
    s_waitcnt lgkmcnt(6)
    v_mfma_f32_16x16x32_bf16 v[122:125], v[118:121], v[92:95], v[122:125]
    v_mfma_f32_32x32x16_bf16 v[32:47], v[92:95], v[136:139], v[32:47]
    v_mul_f32 v67, v67, v22
    v_cvt_pk_bf16_f32 v65, v66, v67
    v_mul_f32 v68, v68, v22
    v_mul_f32 v69, v69, v22
    v_cvt_pk_bf16_f32 v66, v68, v69
    v_mul_f32 v70, v70, v22
    ds_read_b64_tr_b16 v[92:93], v7 offset:6144
    ds_read_b64_tr_b16 v[94:95], v7 offset:6656
    v_mfma_f32_16x16x32_bf16 v[122:125], v[118:121], v[96:99], v[122:125]
    v_mfma_f32_32x32x16_bf16 v[32:47], v[96:99], v[140:143], v[32:47]
    v_mul_f32 v71, v71, v22
    v_cvt_pk_bf16_f32 v67, v70, v71
    buffer_store_dwordx4 v[64:67], v10, s[20:23], s36 offen sc1
    v_mul_f32 v72, v72, v22
    v_mul_f32 v73, v73, v22
    ds_read_b64_tr_b16 v[96:97], v8 offset:0
    ds_read_b64_tr_b16 v[98:99], v8 offset:512
    s_waitcnt lgkmcnt(6)
    v_mfma_f32_32x32x16_bf16 v[32:47], v[80:83], v[144:147], v[32:47]
    v_cvt_pk_bf16_f32 v72, v72, v73
    v_mul_f32 v74, v74, v22
    v_mul_f32 v75, v75, v22
    v_cvt_pk_bf16_f32 v73, v74, v75
    v_mul_f32 v76, v76, v22
    v_mul_f32 v77, v77, v22
    ds_read_b64_tr_b16 v[80:81], v8 offset:2048
    ds_read_b64_tr_b16 v[82:83], v8 offset:2560
    v_mfma_f32_32x32x16_bf16 v[32:47], v[84:87], v[148:151], v[32:47]
    v_cvt_pk_bf16_f32 v74, v76, v77
    v_mul_f32 v78, v78, v22
    v_mul_f32 v79, v79, v22
    v_cvt_pk_bf16_f32 v75, v78, v79
    buffer_store_dwordx4 v[72:75], v10, s[20:23], s37 offen sc1
    ds_read_b64_tr_b16 v[84:85], v8 offset:4096
    ds_read_b64_tr_b16 v[86:87], v8 offset:4608
    s_waitcnt lgkmcnt(6)
    v_mfma_f32_32x32x16_bf16 v[32:47], v[88:91], v[152:155], v[32:47]
    ds_read_b64_tr_b16 v[88:89], v8 offset:6144
    ds_read_b64_tr_b16 v[90:91], v8 offset:6656
    v_mfma_f32_32x32x16_bf16 v[32:47], v[92:95], v[156:159], v[32:47]
    ds_read_b64_tr_b16 v[92:93], v9 offset:0
    ds_read_b64_tr_b16 v[94:95], v9 offset:512
    s_waitcnt lgkmcnt(6)
    v_mfma_f32_32x32x16_bf16 v[32:47], v[96:99], v[160:163], v[32:47]
    ds_read_b64_tr_b16 v[96:97], v9 offset:2048
    ds_read_b64_tr_b16 v[98:99], v9 offset:2560
    v_mfma_f32_32x32x16_bf16 v[32:47], v[80:83], v[164:167], v[32:47]
    ds_read_b64_tr_b16 v[80:81], v9 offset:4096
    ds_read_b64_tr_b16 v[82:83], v9 offset:4608
    s_waitcnt lgkmcnt(6)
    v_mfma_f32_32x32x16_bf16 v[32:47], v[84:87], v[168:171], v[32:47]
    s_barrier
    ds_read_b64_tr_b16 v[84:85], v9 offset:6144
    ds_read_b64_tr_b16 v[86:87], v9 offset:6656
    v_mfma_f32_32x32x16_bf16 v[32:47], v[88:91], v[172:175], v[32:47]
    ds_read_b64_tr_b16 v[88:89], v6 offset:8192
    ds_read_b64_tr_b16 v[90:91], v6 offset:8704
    s_waitcnt lgkmcnt(6)
    v_mfma_f32_32x32x16_bf16 v[32:47], v[92:95], v[176:179], v[32:47]
    ds_read_b64_tr_b16 v[92:93], v6 offset:10240
    ds_read_b64_tr_b16 v[94:95], v6 offset:10752
    v_mfma_f32_32x32x16_bf16 v[32:47], v[96:99], v[180:183], v[32:47]
    ds_read_b64_tr_b16 v[96:97], v6 offset:12288
    ds_read_b64_tr_b16 v[98:99], v6 offset:12800
    s_waitcnt lgkmcnt(6)
    v_mfma_f32_32x32x16_bf16 v[32:47], v[80:83], v[184:187], v[32:47]
    s_waitcnt vmcnt(0)
    s_mov_b64 exec, 1
    buffer_store_dword v31, v10, s[20:23], s46 offen offset:0 sc1
    s_mov_b64 exec, -1
    ds_read_b64_tr_b16 v[80:81], v6 offset:14336
    ds_read_b64_tr_b16 v[82:83], v6 offset:14848
    v_mfma_f32_32x32x16_bf16 v[32:47], v[84:87], v[188:191], v[32:47]
    ds_read_b64_tr_b16 v[84:85], v7 offset:8192
    ds_read_b64_tr_b16 v[86:87], v7 offset:8704
    s_waitcnt lgkmcnt(6)
    v_mfma_f32_16x16x32_bf16 v[122:125], v[118:121], v[88:91], v[122:125]
    v_mfma_f32_32x32x16_bf16 v[32:47], v[88:91], v[192:195], v[32:47]
    s_add_u32 m0, s70, 24576
    s_nop 0
    buffer_load_dwordx4 v2, s[12:15], s69 offen offset:0 lds
    ds_read_b64_tr_b16 v[88:89], v7 offset:10240
    ds_read_b64_tr_b16 v[90:91], v7 offset:10752
    v_mfma_f32_16x16x32_bf16 v[122:125], v[118:121], v[92:95], v[122:125]
    v_mfma_f32_32x32x16_bf16 v[32:47], v[92:95], v[196:199], v[32:47]
    ds_read_b64_tr_b16 v[92:93], v7 offset:12288
    ds_read_b64_tr_b16 v[94:95], v7 offset:12800
    s_waitcnt lgkmcnt(6)
    v_mfma_f32_16x16x32_bf16 v[122:125], v[118:121], v[96:99], v[122:125]
    v_mfma_f32_32x32x16_bf16 v[32:47], v[96:99], v[200:203], v[32:47]
    ds_read_b64_tr_b16 v[96:97], v7 offset:14336
    ds_read_b64_tr_b16 v[98:99], v7 offset:14848
    v_mfma_f32_16x16x32_bf16 v[122:125], v[118:121], v[80:83], v[122:125]
    v_mfma_f32_32x32x16_bf16 v[32:47], v[80:83], v[204:207], v[32:47]
    buffer_load_dwordx4 v3, s[12:15], s69 offen offset:1024 lds
    ds_read_b64_tr_b16 v[80:81], v8 offset:8192
    ds_read_b64_tr_b16 v[82:83], v8 offset:8704
    s_waitcnt lgkmcnt(6)
    v_mfma_f32_32x32x16_bf16 v[32:47], v[84:87], v[208:211], v[32:47]
    ds_read_b64_tr_b16 v[84:85], v8 offset:10240
    ds_read_b64_tr_b16 v[86:87], v8 offset:10752
    v_mfma_f32_32x32x16_bf16 v[32:47], v[88:91], v[212:215], v[32:47]
    ds_read_b64_tr_b16 v[88:89], v8 offset:12288
    ds_read_b64_tr_b16 v[90:91], v8 offset:12800
    s_waitcnt lgkmcnt(6)
    v_mfma_f32_32x32x16_bf16 v[32:47], v[92:95], v[216:219], v[32:47]
    ds_read_b64_tr_b16 v[92:93], v8 offset:14336
    ds_read_b64_tr_b16 v[94:95], v8 offset:14848
    v_mfma_f32_32x32x16_bf16 v[32:47], v[96:99], v[220:223], v[32:47]
    buffer_load_dwordx4 v4, s[12:15], s69 offen offset:2048 lds
    ds_write_b32 v126, v122 offset:512
    ds_read_b64_tr_b16 v[96:97], v9 offset:8192
    ds_read_b64_tr_b16 v[98:99], v9 offset:8704
    s_waitcnt lgkmcnt(7)
    v_mfma_f32_32x32x16_bf16 v[32:47], v[80:83], v[224:227], v[32:47]
    ds_read_b64_tr_b16 v[80:81], v9 offset:10240
    ds_read_b64_tr_b16 v[82:83], v9 offset:10752
    v_mfma_f32_32x32x16_bf16 v[32:47], v[84:87], v[228:231], v[32:47]
    ds_read_b64_tr_b16 v[84:85], v9 offset:12288
    ds_read_b64_tr_b16 v[86:87], v9 offset:12800
    s_waitcnt lgkmcnt(7)
    v_mfma_f32_32x32x16_bf16 v[32:47], v[88:91], v[232:235], v[32:47]
    buffer_load_dwordx4 v5, s[12:15], s69 offen offset:3072 lds
    s_waitcnt lgkmcnt(6)
    s_barrier
    ds_read_b64_tr_b16 v[88:89], v9 offset:14336
    ds_read_b64_tr_b16 v[90:91], v9 offset:14848
    s_mov_b64 exec, 1
    buffer_store_dword v31, v10, s[20:23], s49 offen offset:0 sc1
    s_mov_b64 exec, -1
    v_mfma_f32_32x32x16_bf16 v[32:47], v[92:95], v[236:239], v[32:47]
    ds_read_b128 v[16:19], v28 offset:512
    ds_read_b64_tr_b16 v[92:93], v6 offset:16384
    ds_read_b64_tr_b16 v[94:95], v6 offset:16896
    s_waitcnt lgkmcnt(7)
    v_mfma_f32_32x32x16_bf16 v[32:47], v[96:99], v[240:243], v[32:47]
    ds_read_b64_tr_b16 v[96:97], v6 offset:18432
    ds_read_b64_tr_b16 v[98:99], v6 offset:18944
    v_mfma_f32_32x32x16_bf16 v[32:47], v[80:83], v[244:247], v[32:47]
    buffer_load_dword v111, v109, s[20:23], s58 offen
    s_waitcnt lgkmcnt(4)
    v_add_f32 v16, v16, v17
    v_add_f32 v18, v18, v19
    ds_read_b64_tr_b16 v[80:81], v6 offset:20480
    ds_read_b64_tr_b16 v[82:83], v6 offset:20992
    v_mfma_f32_32x32x16_bf16 v[32:47], v[84:87], v[248:251], v[32:47]
    v_add_f32 v16, v16, v18
    v_cvt_pk_bf16_f32 v117, v16, v16
    v_and_b32 v17, 0xffff0000, v117
    v_sub_f32 v17, v16, v17
    v_cvt_pk_bf16_f32 v116, v16, v17
    ds_read_b64_tr_b16 v[84:85], v6 offset:22528
    ds_read_b64_tr_b16 v[86:87], v6 offset:23040
    v_mfma_f32_32x32x16_bf16 v[32:47], v[88:91], v[252:255], v[32:47]
    v_mfma_f32_32x32x16_bf16 v[32:47], v[116:119], v[24:27], v[32:47]
    s_mul_i32 s73, s3, 81920
    v_add_u32 v2, s73, v10
    v_lshrrev_b32 v4, 5, v1
    v_and_b32 v5, 15, v1
    ds_read_b64_tr_b16 v[88:89], v7 offset:16384
    ds_read_b64_tr_b16 v[90:91], v7 offset:16896
    s_waitcnt lgkmcnt(6)
    v_mfma_f32_16x16x32_bf16 v[122:125], v[118:121], v[92:95], 0
    v_mfma_f32_32x32x16_bf16 v[48:63], v[92:95], v[128:131], 0
    v_lshlrev_b32 v5, 4, v5
    v_lshl_add_u32 v5, v4, 8, v5
    s_add_u32 s73, s73, 40960
    v_add_u32 v3, s73, v5
    ds_read_b64_tr_b16 v[92:93], v7 offset:18432
    ds_read_b64_tr_b16 v[94:95], v7 offset:18944
    v_mfma_f32_16x16x32_bf16 v[122:125], v[118:121], v[96:99], v[122:125]
    v_mfma_f32_32x32x16_bf16 v[48:63], v[96:99], v[132:135], v[48:63]
    v_add_u32 v5, 0x8c00, v5
    v_and_b32 v4, 16, v1
    ds_read_b64_tr_b16 v[96:97], v7 offset:20480
    ds_read_b64_tr_b16 v[98:99], v7 offset:20992
    s_waitcnt lgkmcnt(6)
    v_mfma_f32_16x16x32_bf16 v[122:125], v[118:121], v[80:83], v[122:125]
    v_mfma_f32_32x32x16_bf16 v[48:63], v[80:83], v[136:139], v[48:63]
    v_cmp_eq_u32 vcc, 16, v4
    v_mov_b32 v4, 4096
    s_nop 0
    v_cndmask_b32 v3, v3, v5, vcc
    v_cndmask_b32 v4, v4, 0, vcc
    v_and_b32 v5, 7, v0
    v_mul_f32 v20, v32, v32
    ds_read_b64_tr_b16 v[80:81], v7 offset:22528
    ds_read_b64_tr_b16 v[82:83], v7 offset:23040
    v_mfma_f32_16x16x32_bf16 v[122:125], v[118:121], v[84:87], v[122:125]
    v_mfma_f32_32x32x16_bf16 v[48:63], v[84:87], v[140:143], v[48:63]
    v_lshlrev_b32 v5, 4, v5
    v_lshrrev_b32 v113, 3, v0
    v_lshl_add_u32 v5, v113, 10, v5
    v_mul_f32 v21, v33, v33
    v_fma_f32 v20, v20, v13, v12
    v_fma_f32 v21, v21, v13, v12
    ds_read_b64_tr_b16 v[84:85], v8 offset:16384
    ds_read_b64_tr_b16 v[86:87], v8 offset:16896
    s_waitcnt lgkmcnt(6)
    v_mfma_f32_32x32x16_bf16 v[48:63], v[88:91], v[144:147], v[48:63]
    v_mul_f32 v20, v20, v32
    v_mul_f32 v21, v21, v33
    v_exp_f32 v20, v20
    v_exp_f32 v21, v21
    ds_read_b64_tr_b16 v[88:89], v8 offset:18432
    ds_read_b64_tr_b16 v[90:91], v8 offset:18944
    v_mfma_f32_32x32x16_bf16 v[48:63], v[92:95], v[148:151], v[48:63]
    v_fma_f32 v20, v20, v14, v14
    v_fma_f32 v21, v21, v14, v14
    v_rcp_f32 v20, v20
    v_rcp_f32 v21, v21
    ds_read_b64_tr_b16 v[92:93], v8 offset:20480
    ds_read_b64_tr_b16 v[94:95], v8 offset:20992
    s_waitcnt lgkmcnt(6)
    v_mfma_f32_32x32x16_bf16 v[48:63], v[96:99], v[152:155], v[48:63]
    v_mul_f32 v32, v32, v20
    v_mul_f32 v33, v33, v21
    v_mul_f32 v20, v34, v34
    v_mul_f32 v21, v35, v35
    v_fma_f32 v20, v20, v13, v12
    v_fma_f32 v21, v21, v13, v12
    ds_read_b64_tr_b16 v[96:97], v8 offset:22528
    ds_read_b64_tr_b16 v[98:99], v8 offset:23040
    v_mfma_f32_32x32x16_bf16 v[48:63], v[80:83], v[156:159], v[48:63]
    v_mul_f32 v20, v20, v34
    v_mul_f32 v21, v21, v35
    v_exp_f32 v20, v20
    v_exp_f32 v21, v21
    s_waitcnt vmcnt(0)
    v_cmp_ne_u32 vcc, s59, v111
    s_nop 0
    s_and_b64 vcc, vcc, s[52:53]
    s_cselect_b32 s87, 0x40000000, s54
    ds_read_b64_tr_b16 v[80:81], v9 offset:16384
    ds_read_b64_tr_b16 v[82:83], v9 offset:16896
    s_waitcnt lgkmcnt(6)
    v_mfma_f32_32x32x16_bf16 v[48:63], v[84:87], v[160:163], v[48:63]
    buffer_load_dword v112, v110, s[20:23], s58 offen
    s_add_u32 m0, s70, 0
    s_nop 0
    buffer_load_dwordx4 v10, s[20:23], s87 offen offset:0 lds
    ds_read_b64_tr_b16 v[84:85], v9 offset:18432
    ds_read_b64_tr_b16 v[86:87], v9 offset:18944
    v_mfma_f32_32x32x16_bf16 v[48:63], v[88:91], v[164:167], v[48:63]
    buffer_load_dwordx4 v10, s[20:23], s87 offen offset:1024 lds
    v_fma_f32 v20, v20, v14, v14
    v_fma_f32 v21, v21, v14, v14
    ds_read_b64_tr_b16 v[88:89], v9 offset:20480
    ds_read_b64_tr_b16 v[90:91], v9 offset:20992
    s_waitcnt lgkmcnt(6)
    v_mfma_f32_32x32x16_bf16 v[48:63], v[92:95], v[168:171], v[48:63]
    v_rcp_f32 v20, v20
    v_rcp_f32 v21, v21
    v_mul_f32 v34, v34, v20
    v_mul_f32 v35, v35, v21
    v_mul_f32 v20, v36, v36
    s_barrier
    ds_read_b64_tr_b16 v[92:93], v9 offset:22528
    ds_read_b64_tr_b16 v[94:95], v9 offset:23040
    v_mfma_f32_32x32x16_bf16 v[48:63], v[96:99], v[172:175], v[48:63]
    buffer_load_dwordx4 v10, s[20:23], s87 offen offset:2048 lds
    v_mul_f32 v21, v37, v37
    v_fma_f32 v20, v20, v13, v12
    v_fma_f32 v21, v21, v13, v12
    ds_read_b64_tr_b16 v[96:97], v6 offset:24576
    ds_read_b64_tr_b16 v[98:99], v6 offset:25088
    s_waitcnt lgkmcnt(6)
    v_mfma_f32_32x32x16_bf16 v[48:63], v[80:83], v[176:179], v[48:63]
    v_mul_f32 v20, v20, v36
    v_mul_f32 v21, v21, v37
    v_exp_f32 v20, v20
    v_exp_f32 v21, v21
    ds_read_b64_tr_b16 v[80:81], v6 offset:26624
    ds_read_b64_tr_b16 v[82:83], v6 offset:27136
    v_mfma_f32_32x32x16_bf16 v[48:63], v[84:87], v[180:183], v[48:63]
    buffer_load_dwordx4 v10, s[20:23], s87 offen offset:3072 lds
    v_fma_f32 v20, v20, v14, v14
    v_fma_f32 v21, v21, v14, v14
    v_rcp_f32 v20, v20
    ds_read_b64_tr_b16 v[84:85], v6 offset:28672
    ds_read_b64_tr_b16 v[86:87], v6 offset:29184
    s_waitcnt lgkmcnt(6)
    v_mfma_f32_32x32x16_bf16 v[48:63], v[88:91], v[184:187], v[48:63]
    v_rcp_f32 v21, v21
    v_mul_f32 v36, v36, v20
    v_mul_f32 v37, v37, v21
    v_mul_f32 v20, v38, v38
    ds_read_b64_tr_b16 v[88:89], v6 offset:30720
    ds_read_b64_tr_b16 v[90:91], v6 offset:31232
    v_mfma_f32_32x32x16_bf16 v[48:63], v[92:95], v[188:191], v[48:63]
    v_mul_f32 v21, v39, v39
    v_fma_f32 v20, v20, v13, v12
    v_fma_f32 v21, v21, v13, v12
    v_mul_f32 v20, v20, v38
    v_mul_f32 v21, v21, v39
    v_exp_f32 v20, v20
    ds_read_b64_tr_b16 v[92:93], v7 offset:24576
    ds_read_b64_tr_b16 v[94:95], v7 offset:25088
    s_waitcnt lgkmcnt(6)
    v_mfma_f32_16x16x32_bf16 v[122:125], v[118:121], v[96:99], v[122:125]
    v_mfma_f32_32x32x16_bf16 v[48:63], v[96:99], v[192:195], v[48:63]
    v_exp_f32 v21, v21
    v_fma_f32 v20, v20, v14, v14
    v_fma_f32 v21, v21, v14, v14
    v_rcp_f32 v20, v20
    ds_read_b64_tr_b16 v[96:97], v7 offset:26624
    ds_read_b64_tr_b16 v[98:99], v7 offset:27136
    v_mfma_f32_16x16x32_bf16 v[122:125], v[118:121], v[80:83], v[122:125]
    v_mfma_f32_32x32x16_bf16 v[48:63], v[80:83], v[196:199], v[48:63]
    v_rcp_f32 v21, v21
    v_mul_f32 v38, v38, v20
    v_mul_f32 v39, v39, v21
    v_mul_f32 v20, v40, v40
    ds_read_b64_tr_b16 v[80:81], v7 offset:28672
    ds_read_b64_tr_b16 v[82:83], v7 offset:29184
    s_waitcnt lgkmcnt(6)
    v_mfma_f32_16x16x32_bf16 v[122:125], v[118:121], v[84:87], v[122:125]
    v_mfma_f32_32x32x16_bf16 v[48:63], v[84:87], v[200:203], v[48:63]
    s_waitcnt vmcnt(4)
    v_cmp_ne_u32 vcc, s59, v112
    s_nop 0
    s_andn2_b64 vcc, vcc, s[52:53]
    s_cselect_b32 s88, 0x40000000, s55
    buffer_load_dwordx4 v[100:103], v10, s[20:23], s88 offen
    buffer_load_dwordx4 v[104:107], v10, s[20:23], s88 offen offset:1024
    ds_read_b64_tr_b16 v[84:85], v7 offset:30720
    ds_read_b64_tr_b16 v[86:87], v7 offset:31232
    v_mfma_f32_16x16x32_bf16 v[122:125], v[118:121], v[88:91], v[122:125]
    v_mfma_f32_32x32x16_bf16 v[48:63], v[88:91], v[204:207], v[48:63]
    v_mul_f32 v21, v41, v41
    v_fma_f32 v20, v20, v13, v12
    v_fma_f32 v21, v21, v13, v12
    v_mul_f32 v20, v20, v40
    v_mul_f32 v21, v21, v41
    v_exp_f32 v20, v20
    ds_read_b64_tr_b16 v[88:89], v8 offset:24576
    ds_read_b64_tr_b16 v[90:91], v8 offset:25088
    s_waitcnt lgkmcnt(6)
    v_mfma_f32_32x32x16_bf16 v[48:63], v[92:95], v[208:211], v[48:63]
    v_exp_f32 v21, v21
    v_fma_f32 v20, v20, v14, v14
    v_fma_f32 v21, v21, v14, v14
    v_rcp_f32 v20, v20
    ds_read_b64_tr_b16 v[92:93], v8 offset:26624
    ds_read_b64_tr_b16 v[94:95], v8 offset:27136
    v_mfma_f32_32x32x16_bf16 v[48:63], v[96:99], v[212:215], v[48:63]
    s_add_u32 m0, s70, 8192
    s_add_u32 s87, s87, 8192
    buffer_load_dwordx4 v10, s[20:23], s87 offen offset:0 lds
    v_rcp_f32 v21, v21
    ds_read_b64_tr_b16 v[96:97], v8 offset:28672
    ds_read_b64_tr_b16 v[98:99], v8 offset:29184
    s_waitcnt lgkmcnt(6)
    v_mfma_f32_32x32x16_bf16 v[48:63], v[80:83], v[216:219], v[48:63]
    s_or_b32 s89, s87, s88
    s_bitcmp1_b32 s89, 30
    s_cselect_b32 s89, s58, 0x40000000
    buffer_load_dword v127, v108, s[20:23], s89 offen sc1
    s_setprio 3
    v_mul_f32 v40, v40, v20
    ds_read_b64_tr_b16 v[80:81], v8 offset:30720
    ds_read_b64_tr_b16 v[82:83], v8 offset:31232
    v_mfma_f32_32x32x16_bf16 v[48:63], v[84:87], v[220:223], v[48:63]
    buffer_load_dwordx4 v10, s[20:23], s87 offen offset:1024 lds
    ds_write_b32 v126, v122 offset:0
    v_mul_f32 v41, v41, v21
    v_mul_f32 v20, v42, v42
    v_mul_f32 v21, v43, v43
    ds_read_b64_tr_b16 v[84:85], v9 offset:24576
    ds_read_b64_tr_b16 v[86:87], v9 offset:25088
    s_waitcnt lgkmcnt(7)
    v_mfma_f32_32x32x16_bf16 v[48:63], v[88:91], v[224:227], v[48:63]
    v_fma_f32 v20, v20, v13, v12
    v_fma_f32 v21, v21, v13, v12
    v_mul_f32 v20, v20, v42
    v_mul_f32 v21, v21, v43
    v_exp_f32 v20, v20
    ds_read_b64_tr_b16 v[88:89], v9 offset:26624
    ds_read_b64_tr_b16 v[90:91], v9 offset:27136
    v_mfma_f32_32x32x16_bf16 v[48:63], v[92:95], v[228:231], v[48:63]
    buffer_load_dwordx4 v10, s[20:23], s87 offen offset:2048 lds
    v_exp_f32 v21, v21
    v_fma_f32 v20, v20, v14, v14
    ds_read_b64_tr_b16 v[92:93], v9 offset:28672
    ds_read_b64_tr_b16 v[94:95], v9 offset:29184
    s_waitcnt lgkmcnt(7)
    v_mfma_f32_32x32x16_bf16 v[48:63], v[96:99], v[232:235], v[48:63]
    v_fma_f32 v21, v21, v14, v14
    v_rcp_f32 v20, v20
    v_rcp_f32 v21, v21
    v_mul_f32 v42, v42, v20
    s_waitcnt lgkmcnt(6)
    s_barrier
    ds_read_b64_tr_b16 v[96:97], v9 offset:30720
    ds_read_b64_tr_b16 v[98:99], v9 offset:31232
    v_mfma_f32_32x32x16_bf16 v[48:63], v[80:83], v[236:239], v[48:63]
    buffer_load_dwordx4 v10, s[20:23], s87 offen offset:3072 lds
    ds_read_b128 v[16:19], v28 offset:0
    v_mul_f32 v43, v43, v21
    v_mul_f32 v20, v44, v44
    s_waitcnt lgkmcnt(5)
    v_mfma_f32_32x32x16_bf16 v[48:63], v[84:87], v[240:243], v[48:63]
    s_bitcmp0_b32 s87, 30
    s_cselect_b32 s72, 1, 0
    v_mov_b32 v113, s72
    s_waitcnt vmcnt(7)
    s_mov_b64 exec, 1
    ds_add_u32 v26, v113 offset:34816
    s_mov_b64 exec, -1
    v_mul_f32 v21, v45, v45
    v_fma_f32 v20, v20, v13, v12
    v_fma_f32 v21, v21, v13, v12
    v_mul_f32 v20, v20, v44
    v_mul_f32 v21, v21, v45
    v_exp_f32 v20, v20
    v_mfma_f32_32x32x16_bf16 v[48:63], v[88:91], v[244:247], v[48:63]
    s_waitcnt lgkmcnt(1)
    v_add_f32 v16, v16, v17
    v_add_f32 v18, v18, v19
    v_add_f32 v16, v16, v18
    v_exp_f32 v21, v21
    v_mfma_f32_32x32x16_bf16 v[48:63], v[92:95], v[248:251], v[48:63]
    v_cvt_pk_bf16_f32 v117, v16, v16
    v_and_b32 v17, 0xffff0000, v117
    v_sub_f32 v17, v16, v17
    v_cvt_pk_bf16_f32 v116, v16, v17
    v_fma_f32 v20, v20, v14, v14
    v_fma_f32 v21, v21, v14, v14
    v_mfma_f32_32x32x16_bf16 v[48:63], v[96:99], v[252:255], v[48:63]
    v_mfma_f32_32x32x16_bf16 v[48:63], v[116:119], v[24:27], v[48:63]
    v_rcp_f32 v20, v20
    v_rcp_f32 v21, v21
    v_mul_f32 v44, v44, v20
    v_mul_f32 v45, v45, v21
    v_mul_f32 v20, v46, v46
    v_mul_f32 v21, v47, v47
    v_fma_f32 v20, v20, v13, v12
    v_fma_f32 v21, v21, v13, v12
    v_mul_f32 v20, v20, v46
    v_mul_f32 v21, v21, v47
    v_exp_f32 v20, v20
    v_exp_f32 v21, v21
    v_fma_f32 v20, v20, v14, v14
    v_fma_f32 v21, v21, v14, v14
    v_rcp_f32 v20, v20
    v_rcp_f32 v21, v21
    v_mul_f32 v46, v46, v20
    v_mul_f32 v47, v47, v21
    v_mul_f32 v48, v48, v32
    v_mul_f32 v49, v49, v33
    v_cvt_pk_bf16_f32 v32, v48, v49
    v_mul_f32 v50, v50, v34
    v_mul_f32 v51, v51, v35
    v_cvt_pk_bf16_f32 v33, v50, v51
    v_mul_f32 v52, v52, v36
    v_mul_f32 v53, v53, v37
    v_cvt_pk_bf16_f32 v34, v52, v53
    v_mul_f32 v54, v54, v38
    v_mul_f32 v55, v55, v39
    v_cvt_pk_bf16_f32 v35, v54, v55
    buffer_store_dwordx4 v[32:35], v10, s[20:23], s42 offen offset:0 sc1
    v_mul_f32 v56, v56, v40
    ds_read_b32 v114, v26 offset:34816
    v_mul_f32 v57, v57, v41
    v_cvt_pk_bf16_f32 v40, v56, v57
    v_mul_f32 v58, v58, v42
    v_mul_f32 v59, v59, v43
    v_cvt_pk_bf16_f32 v41, v58, v59
    v_mul_f32 v60, v60, v44
    v_mul_f32 v61, v61, v45
    v_cvt_pk_bf16_f32 v42, v60, v61
    v_mul_f32 v62, v62, v46
    v_mul_f32 v63, v63, v47
    v_cvt_pk_bf16_f32 v43, v62, v63
    buffer_store_dwordx4 v[40:43], v10, s[20:23], s42 offen offset:1024 sc1
    s_or_b32 s72, s87, s88
    s_bitcmp1_b32 s72, 30
    s_cbranch_scc0 K1b_havekv
    s_waitcnt vmcnt(5)
    v_cmp_ne_u32 vcc, s59, v127
    s_nop 0
    s_andn2_b64 vcc, vcc, s[52:53]
    s_nop 2
    s_cbranch_vccz K1b_fq1
    s_mov_b32 s74, 262144
K1b_fq0:
    buffer_load_dword v127, v108, s[20:23], s58 offen sc1
    s_waitcnt vmcnt(0)
    v_cmp_ne_u32 vcc, s59, v127
    s_nop 0
    s_andn2_b64 vcc, vcc, s[52:53]
    s_nop 2
    s_cbranch_vccz K1b_fq1
    s_sub_u32 s74, s74, 1
    s_cbranch_scc0 K1b_fq0
K1b_fq1:
    s_mov_b32 s88, s55
    buffer_load_dwordx4 v[100:103], v10, s[20:23], s88 offen
    buffer_load_dwordx4 v[104:107], v10, s[20:23], s88 offen offset:1024
    s_bitcmp1_b32 s87, 30
    s_cbranch_scc0 K1b_kvok
    v_cmp_ne_u32 vcc, s59, v127
    s_nop 0
    s_and_b64 vcc, vcc, s[52:53]
    s_nop 2
    s_cbranch_vccz K1b_fl1
    s_mov_b32 s74, 262144
K1b_fl0:
    buffer_load_dword v127, v108, s[20:23], s58 offen sc1
    s_waitcnt vmcnt(0)
    v_cmp_ne_u32 vcc, s59, v127
    s_nop 0
    s_and_b64 vcc, vcc, s[52:53]
    s_nop 2
    s_cbranch_vccz K1b_fl1
    s_sub_u32 s74, s74, 1
    s_cbranch_scc0 K1b_fl0
K1b_fl1:
    s_mov_b32 s87, s54
    s_add_u32 m0, s70, 0
    s_nop 0
    buffer_load_dwordx4 v10, s[20:23], s87 offen offset:0 lds
    buffer_load_dwordx4 v10, s[20:23], s87 offen offset:1024 lds
    buffer_load_dwordx4 v10, s[20:23], s87 offen offset:2048 lds
    buffer_load_dwordx4 v10, s[20:23], s87 offen offset:3072 lds
    s_add_u32 m0, s70, 8192
    s_add_u32 s87, s87, 8192
    buffer_load_dwordx4 v10, s[20:23], s87 offen offset:0 lds
    buffer_load_dwordx4 v10, s[20:23], s87 offen offset:1024 lds
    buffer_load_dwordx4 v10, s[20:23], s87 offen offset:2048 lds
    buffer_load_dwordx4 v10, s[20:23], s87 offen offset:3072 lds
    v_mov_b32 v113, 1
    s_waitcnt vmcnt(4)
    s_mov_b64 exec, 1
    ds_add_u32 v26, v113 offset:34816
    s_mov_b64 exec, -1
K1b_kvok:
    s_waitcnt vmcnt(0)
K1b_havekv:
    s_add_u32 s54, s54, 8192
    s_waitcnt vmcnt(7)
K1b_end:
K2_start:
    s_waitcnt lgkmcnt(0)
    v_readfirstlane_b32 s73, v114
    s_nop 0
    s_bitcmp1_b32 s73, 3
    s_cbranch_scc1 K2_c0_ok
    s_mov_b32 s94, 2097152
    v_mov_b32 v109, 34816
K2_c0:
    ds_read_b32 v108, v109
    s_waitcnt lgkmcnt(0)
    v_readfirstlane_b32 s73, v108
    s_nop 0
    s_bitcmp1_b32 s73, 3
    s_cbranch_scc1 K2_c0_ok
    s_sleep 1
    s_sub_u32 s94, s94, 1
    s_cbranch_scc0 K2_c0
K2_c0_ok:
    ds_read_b128 v[12:15], v2
    ds_read_b128 v[16:19], v2 offset:1024
    s_setprio 3
    s_mov_b32 s96, 0
    v_mov_b32 v44, s59
    v_mov_b32 v8, 0x100
    v_mov_b32 v9, 0x10000
    v_mov_b32 v6, 0x1000000
    v_mov_b32 v45, 34816
    s_mov_b32 s8, s50
    s_mov_b32 s9, s51
    s_mov_b32 s10, 2097152
    s_mov_b32 s11, 0x00020000
    s_waitcnt lgkmcnt(1)
    v_mfma_f32_32x32x16_bf16 v[128:143], v[12:15], v[100:103], 0
    v_mfma_f32_32x32x16_bf16 v[144:159], v[12:15], v[104:107], 0
    v_and_b32 v46, 31, v1
    v_lshlrev_b32 v46, 2, v46
    v_mov_b32 v40, 0
    v_mov_b32 v41, 0
    v_mov_b32 v42, 0
    v_mov_b32 v43, 0
    s_nop 4
    v_max3_f32 v108, v128, v129, v130
    v_max3_f32 v108, v108, v131, v132
    v_max3_f32 v108, v108, v133, v134
    v_max3_f32 v108, v108, v135, v136
    v_max3_f32 v108, v108, v137, v138
    v_max3_f32 v108, v108, v139, v140
    v_max3_f32 v108, v108, v141, v142
    v_max_f32 v108, v108, v143
    v_max3_f32 v110, v144, v145, v146
    v_max3_f32 v110, v110, v147, v148
    v_max3_f32 v110, v110, v149, v150
    v_max3_f32 v110, v110, v151, v152
    v_max3_f32 v110, v110, v153, v154
    v_max3_f32 v110, v110, v155, v156
    v_max3_f32 v110, v110, v157, v158
    v_max_f32 v110, v110, v159
K2_restart:
    v_mov_b32 v109, v108
    v_mov_b32 v111, v110
    ds_read_b128 v[20:23], v3
    ds_read_b128 v[24:27], v3 offset:512
    v_permlane32_swap_b32 v108, v109
    v_permlane32_swap_b32 v110, v111
    v_max_f32 v108, v108, v109
    v_max_f32 v110, v110, v111
    v_sub_f32 v128, 0, v108
    v_sub_f32 v129, 0, v108
    v_sub_f32 v130, 0, v108
    v_sub_f32 v131, 0, v108
    v_sub_f32 v132, 0, v108
    v_sub_f32 v133, 0, v108
    v_sub_f32 v134, 0, v108
    v_sub_f32 v135, 0, v108
    v_sub_f32 v136, 0, v108
    v_sub_f32 v137, 0, v108
    v_sub_f32 v138, 0, v108
    v_sub_f32 v139, 0, v108
    v_sub_f32 v140, 0, v108
    v_sub_f32 v141, 0, v108
    v_sub_f32 v142, 0, v108
    v_sub_f32 v143, 0, v108
    s_mov_b32 s95, 8
    s_cmp_lg_u32 s96, 0
    v_mfma_f32_32x32x16_bf16 v[48:63], v[12:15], v[100:103], v[128:143]
    v_sub_f32 v144, 0, v110
    v_sub_f32 v145, 0, v110
    v_sub_f32 v146, 0, v110
    v_sub_f32 v147, 0, v110
    v_sub_f32 v148, 0, v110
    v_sub_f32 v149, 0, v110
    v_sub_f32 v150, 0, v110
    v_sub_f32 v151, 0, v110
    v_sub_f32 v152, 0, v110
    v_sub_f32 v153, 0, v110
    v_sub_f32 v154, 0, v110
    v_sub_f32 v155, 0, v110
    v_sub_f32 v156, 0, v110
    v_sub_f32 v157, 0, v110
    v_sub_f32 v158, 0, v110
    v_sub_f32 v159, 0, v110
    s_cbranch_scc1 K2_plain
    s_waitcnt lgkmcnt(0)
    v_mfma_f32_32x32x16_bf16 v[64:79], v[12:15], v[104:107], v[144:159]
    ds_read_b128 v[12:15], v2 offset:2048
    ds_read_b128 v[28:31], v3 offset:1024
    s_and_b32 s94, s2, 7
    s_lshl_b32 s94, s94, 2
    s_bfe_u32 s72, s2, 0x20003
    s_add_u32 s94, s94, s72
    s_lshr_b32 s97, s2, 5
    s_lshl_b32 s72, s94, 1
    s_bfe_u32 s73, s32, 0x10001
    s_add_u32 s72, s72, s73
    s_mul_i32 s84, s72, 114688
    s_lshl_b32 s87, s72, 15
    s_lshl_b32 s91, s72, 7
    s_add_u32 s91, s91, 0x1204000
    s_mul_i32 s90, s73, 8704
    s_and_b32 s72, s32, 1
    s_lshl_b32 s73, s3, 1
    s_add_u32 s73, s73, s72
    s_mul_i32 s72, s73, 28672
    s_add_u32 s84, s84, s72
    s_add_u32 s84, s84, 0x600000
    s_lshl_b32 s88, s73, 13
    s_add_u32 s87, s87, s88
    s_add_u32 s87, s87, 0x1000000
    s_add_u32 s88, s87, 4096
    s_lshl_b32 s85, s97, 11
    v_exp_f32 v48, v48
    v_exp_f32 v49, v49
    v_exp_f32 v50, v50
    v_cvt_pk_bf16_f32 v36, v48, v49
    v_exp_f32 v51, v51
    v_exp_f32 v52, v52
    v_mfma_f32_32x32x16_bf16 v[160:175], v[40:43], v[40:43], 0
    ds_read_b128 v[32:35], v3 offset:1536
    v_cvt_pk_bf16_f32 v37, v50, v51
    v_exp_f32 v53, v53
    v_exp_f32 v54, v54
    v_cvt_pk_bf16_f32 v38, v52, v53
    v_exp_f32 v55, v55
    v_exp_f32 v56, v56
    v_mfma_f32_32x32x16_bf16 v[176:191], v[40:43], v[40:43], 0
    v_cvt_pk_bf16_f32 v39, v54, v55
    v_exp_f32 v57, v57
    v_exp_f32 v58, v58
    v_exp_f32 v59, v59
    v_cvt_pk_bf16_f32 v40, v56, v57
    v_mfma_f32_32x32x16_bf16 v[80:95], v[20:23], v[36:39], 0
    v_exp_f32 v60, v60
    v_exp_f32 v61, v61
    v_cvt_pk_bf16_f32 v41, v58, v59
    v_exp_f32 v62, v62
    v_exp_f32 v63, v63
    v_cvt_pk_bf16_f32 v42, v60, v61
    v_cvt_pk_bf16_f32 v43, v62, v63
    v_mfma_f32_32x32x16_bf16 v[48:63], v[16:19], v[100:103], v[128:143]
    s_lshl_b32 s72, s73, 17
    s_add_u32 s86, s85, s72
    s_add_u32 s86, s86, 0xec0000
    s_mul_i32 s72, s73, 458752
    s_add_u32 s85, s85, s72
    s_add_u32 s85, s85, 0xd00000
    s_mul_i32 s72, s73, 17408
    s_add_u32 s90, s90, s72
    s_lshl_b32 s89, s94, 16
    s_lshl_b32 s72, s97, 7
    s_add_u32 s89, s89, s72
    s_mul_i32 s72, s32, 11
    s_lshr_b32 s72, s72, 5
    s_mul_i32 s72, s72, 33280
    s_mul_i32 s73, s32, 2560
    s_add_u32 s72, s72, s73
    s_add_u32 s92, s72, 73728
    s_xor_b32 s94, s32, 4
    s_mul_i32 s72, s94, 11
    s_lshr_b32 s72, s72, 5
    s_mul_i32 s72, s72, 33280
    s_mul_i32 s73, s94, 2560
    s_add_u32 s72, s72, s73
    s_add_u32 s93, s72, 73728
    v_exp_f32 v64, v64
    v_exp_f32 v65, v65
    v_exp_f32 v66, v66
    v_cvt_pk_bf16_f32 v36, v64, v65
    v_exp_f32 v67, v67
    v_exp_f32 v68, v68
    v_cvt_pk_bf16_f32 v37, v66, v67
    v_exp_f32 v69, v69
    v_mfma_f32_32x32x16_bf16 v[80:95], v[24:27], v[40:43], v[80:95]
    v_exp_f32 v70, v70
    v_cvt_pk_bf16_f32 v38, v68, v69
    v_exp_f32 v71, v71
    v_exp_f32 v72, v72
    v_cvt_pk_bf16_f32 v39, v70, v71
    v_exp_f32 v73, v73
    v_exp_f32 v74, v74
    v_mfma_f32_32x32x16_bf16 v[112:127], v[20:23], v[36:39], 0
    v_exp_f32 v75, v75
    v_cvt_pk_bf16_f32 v40, v72, v73
    v_exp_f32 v76, v76
    v_exp_f32 v77, v77
    v_cvt_pk_bf16_f32 v41, v74, v75
    v_exp_f32 v78, v78
    v_exp_f32 v79, v79
    v_cvt_pk_bf16_f32 v42, v76, v77
    v_cvt_pk_bf16_f32 v43, v78, v79
    s_waitcnt lgkmcnt(0)
    v_mfma_f32_32x32x16_bf16 v[64:79], v[16:19], v[104:107], v[144:159]
    ds_read_b128 v[16:19], v2 offset:3072
    ds_read_b128 v[20:23], v3 offset:2048
    s_waitcnt vmcnt(0)
    s_mov_b64 exec, 1
    buffer_store_dword v44, v10, s[20:23], s48 offen sc1
    ds_add_u32 v45, v8
    s_mov_b64 exec, -1
    s_setprio 2
    v_exp_f32 v48, v48
    v_exp_f32 v49, v49
    v_exp_f32 v50, v50
    v_cvt_pk_bf16_f32 v36, v48, v49
    v_exp_f32 v51, v51
    v_exp_f32 v52, v52
    v_cvt_pk_bf16_f32 v37, v50, v51
    v_exp_f32 v53, v53
    v_mfma_f32_32x32x16_bf16 v[112:127], v[24:27], v[40:43], v[112:127]
    ds_read_b128 v[24:27], v3 offset:2560
    v_exp_f32 v54, v54
    v_cvt_pk_bf16_f32 v38, v52, v53
    v_exp_f32 v55, v55
    v_exp_f32 v56, v56
    v_cvt_pk_bf16_f32 v39, v54, v55
    v_exp_f32 v57, v57
    v_exp_f32 v58, v58
    v_mfma_f32_32x32x16_bf16 v[80:95], v[28:31], v[36:39], v[80:95]
    v_exp_f32 v59, v59
    v_cvt_pk_bf16_f32 v40, v56, v57
    v_exp_f32 v60, v60
    v_exp_f32 v61, v61
    v_cvt_pk_bf16_f32 v41, v58, v59
    v_exp_f32 v62, v62
    v_exp_f32 v63, v63
    v_cvt_pk_bf16_f32 v42, v60, v61
    v_cvt_pk_bf16_f32 v43, v62, v63
    v_mfma_f32_32x32x16_bf16 v[48:63], v[12:15], v[100:103], v[128:143]
    s_add_u32 m0, s70, 16384
    s_add_u32 s54, s54, 8192
    buffer_load_dwordx4 v10, s[20:23], s54 offen offset:0 lds
    buffer_load_dwordx4 v10, s[20:23], s54 offen offset:1024 lds
    buffer_load_dwordx4 v10, s[20:23], s54 offen offset:2048 lds
    buffer_load_dwordx4 v10, s[20:23], s54 offen offset:3072 lds
    v_exp_f32 v64, v64
    v_exp_f32 v65, v65
    v_exp_f32 v66, v66
    v_cvt_pk_bf16_f32 v36, v64, v65
    v_exp_f32 v67, v67
    v_exp_f32 v68, v68
    v_cvt_pk_bf16_f32 v37, v66, v67
    v_exp_f32 v69, v69
    v_mfma_f32_32x32x16_bf16 v[80:95], v[32:35], v[40:43], v[80:95]
    v_exp_f32 v70, v70
    v_cvt_pk_bf16_f32 v38, v68, v69
    v_exp_f32 v71, v71
    v_exp_f32 v72, v72
    v_cvt_pk_bf16_f32 v39, v70, v71
    v_exp_f32 v73, v73
    v_exp_f32 v74, v74
    v_mfma_f32_32x32x16_bf16 v[112:127], v[28:31], v[36:39], v[112:127]
    v_exp_f32 v75, v75
    v_cvt_pk_bf16_f32 v40, v72, v73
    v_exp_f32 v76, v76
    v_exp_f32 v77, v77
    v_cvt_pk_bf16_f32 v41, v74, v75
    v_exp_f32 v78, v78
    v_exp_f32 v79, v79
    v_cvt_pk_bf16_f32 v42, v76, v77
    v_cvt_pk_bf16_f32 v43, v78, v79
    s_waitcnt lgkmcnt(0)
    v_mfma_f32_32x32x16_bf16 v[64:79], v[12:15], v[104:107], v[144:159]
    ds_read_b128 v[12:15], v2 offset:4096
    ds_read_b128 v[28:31], v3 offset:3072
    buffer_load_dwordx4 v[96:99], v5, s[4:7], s89 offen
    s_mov_b32 s72, 0x1208000
    buffer_load_dwordx4 v[192:195], v10, s[20:23], s72 offen
    v_exp_f32 v48, v48
    v_exp_f32 v49, v49
    v_exp_f32 v50, v50
    v_cvt_pk_bf16_f32 v36, v48, v49
    v_exp_f32 v51, v51
    v_exp_f32 v52, v52
    v_cvt_pk_bf16_f32 v37, v50, v51
    v_exp_f32 v53, v53
    v_mfma_f32_32x32x16_bf16 v[112:127], v[32:35], v[40:43], v[112:127]
    ds_read_b128 v[32:35], v3 offset:3584
    v_exp_f32 v54, v54
    v_cvt_pk_bf16_f32 v38, v52, v53
    v_exp_f32 v55, v55
    v_exp_f32 v56, v56
    v_cvt_pk_bf16_f32 v39, v54, v55
    v_exp_f32 v57, v57
    v_exp_f32 v58, v58
    v_mfma_f32_32x32x16_bf16 v[80:95], v[20:23], v[36:39], v[80:95]
    v_exp_f32 v59, v59
    v_cvt_pk_bf16_f32 v40, v56, v57
    v_exp_f32 v60, v60
    v_exp_f32 v61, v61
    v_cvt_pk_bf16_f32 v41, v58, v59
    v_exp_f32 v62, v62
    v_exp_f32 v63, v63
    v_cvt_pk_bf16_f32 v42, v60, v61
    v_cvt_pk_bf16_f32 v43, v62, v63
    v_mfma_f32_32x32x16_bf16 v[48:63], v[16:19], v[100:103], v[128:143]
    v_exp_f32 v64, v64
    v_exp_f32 v65, v65
    v_exp_f32 v66, v66
    v_cvt_pk_bf16_f32 v36, v64, v65
    v_exp_f32 v67, v67
    v_exp_f32 v68, v68
    v_cvt_pk_bf16_f32 v37, v66, v67
    v_exp_f32 v69, v69
    v_mfma_f32_32x32x16_bf16 v[80:95], v[24:27], v[40:43], v[80:95]
    v_exp_f32 v70, v70
    v_cvt_pk_bf16_f32 v38, v68, v69
    v_exp_f32 v71, v71
    v_exp_f32 v72, v72
    v_cvt_pk_bf16_f32 v39, v70, v71
    v_exp_f32 v73, v73
    v_exp_f32 v74, v74
    v_mfma_f32_32x32x16_bf16 v[112:127], v[20:23], v[36:39], v[112:127]
    v_exp_f32 v75, v75
    v_cvt_pk_bf16_f32 v40, v72, v73
    v_exp_f32 v76, v76
    v_exp_f32 v77, v77
    v_cvt_pk_bf16_f32 v41, v74, v75
    v_exp_f32 v78, v78
    v_exp_f32 v79, v79
    v_cvt_pk_bf16_f32 v42, v76, v77
    v_cvt_pk_bf16_f32 v43, v78, v79
    s_waitcnt lgkmcnt(0)
    v_mfma_f32_32x32x16_bf16 v[64:79], v[16:19], v[104:107], v[144:159]
    ds_read_b128 v[16:19], v2 offset:5120
    ds_read_b128 v[20:23], v3 offset:4096
    ds_read_b32 v108, v45
    v_exp_f32 v48, v48
    v_exp_f32 v49, v49
    v_exp_f32 v50, v50
    v_cvt_pk_bf16_f32 v36, v48, v49
    v_exp_f32 v51, v51
    v_exp_f32 v52, v52
    v_cvt_pk_bf16_f32 v37, v50, v51
    v_exp_f32 v53, v53
    v_mfma_f32_32x32x16_bf16 v[112:127], v[24:27], v[40:43], v[112:127]
    ds_read_b128 v[24:27], v3 offset:4608
    v_exp_f32 v54, v54
    v_cvt_pk_bf16_f32 v38, v52, v53
    v_exp_f32 v55, v55
    v_exp_f32 v56, v56
    v_cvt_pk_bf16_f32 v39, v54, v55
    v_exp_f32 v57, v57
    v_exp_f32 v58, v58
    v_mfma_f32_32x32x16_bf16 v[80:95], v[28:31], v[36:39], v[80:95]
    v_exp_f32 v59, v59
    v_cvt_pk_bf16_f32 v40, v56, v57
    v_exp_f32 v60, v60
    v_exp_f32 v61, v61
    v_cvt_pk_bf16_f32 v41, v58, v59
    v_exp_f32 v62, v62
    v_exp_f32 v63, v63
    v_cvt_pk_bf16_f32 v42, v60, v61
    v_cvt_pk_bf16_f32 v43, v62, v63
    v_mfma_f32_32x32x16_bf16 v[48:63], v[12:15], v[100:103], v[128:143]
    v_add_u32 v2, 4096, v2
    v_add_u32 v3, v4, v3
    v_exp_f32 v64, v64
    v_exp_f32 v65, v65
    v_exp_f32 v66, v66
    v_cvt_pk_bf16_f32 v36, v64, v65
    v_exp_f32 v67, v67
    v_exp_f32 v68, v68
    v_cvt_pk_bf16_f32 v37, v66, v67
    v_exp_f32 v69, v69
    v_mfma_f32_32x32x16_bf16 v[80:95], v[32:35], v[40:43], v[80:95]
    v_exp_f32 v70, v70
    v_cvt_pk_bf16_f32 v38, v68, v69
    v_exp_f32 v71, v71
    v_exp_f32 v72, v72
    v_cvt_pk_bf16_f32 v39, v70, v71
    v_exp_f32 v73, v73
    v_exp_f32 v74, v74
    v_mfma_f32_32x32x16_bf16 v[112:127], v[28:31], v[36:39], v[112:127]
    v_exp_f32 v75, v75
    v_cvt_pk_bf16_f32 v40, v72, v73
    v_exp_f32 v76, v76
    v_exp_f32 v77, v77
    v_cvt_pk_bf16_f32 v41, v74, v75
    v_exp_f32 v78, v78
    v_exp_f32 v79, v79
    v_cvt_pk_bf16_f32 v42, v76, v77
    v_cvt_pk_bf16_f32 v43, v78, v79
    s_waitcnt vmcnt(0)
    s_mov_b64 exec, 1
    ds_add_u32 v45, v9
    s_mov_b64 exec, -1
    s_setprio 1
    s_mov_b32 s95, 1
    s_waitcnt lgkmcnt(0)
    v_readfirstlane_b32 s73, v108
    s_nop 0
    s_bitcmp1_b32 s73, 11
    s_cbranch_scc1 K2_c1_ok
    s_mov_b32 s94, 2097152
    v_mov_b32 v109, 34816
K2_c1:
    ds_read_b32 v108, v109
    s_waitcnt lgkmcnt(0)
    v_readfirstlane_b32 s73, v108
    s_nop 0
    s_bitcmp1_b32 s73, 11
    s_cbranch_scc1 K2_c1_ok
    s_sleep 1
    s_sub_u32 s94, s94, 1
    s_cbranch_scc0 K2_c1
K2_c1_ok:
    s_add_u32 m0, s70, 24576
    s_add_u32 s54, s54, 8192
    buffer_load_dwordx4 v10, s[20:23], s54 offen offset:0 lds
    buffer_load_dwordx4 v10, s[20:23], s54 offen offset:1024 lds
    buffer_load_dwordx4 v10, s[20:23], s54 offen offset:2048 lds
    buffer_load_dwordx4 v10, s[20:23], s54 offen offset:3072 lds
K2_plain:
    s_waitcnt lgkmcnt(0)
    v_mfma_f32_32x32x16_bf16 v[64:79], v[12:15], v[104:107], v[144:159]
    ds_read_b128 v[12:15], v2 offset:2048
    ds_read_b128 v[28:31], v3 offset:1024
    v_exp_f32 v48, v48
    v_exp_f32 v49, v49
    v_exp_f32 v50, v50
    v_cvt_pk_bf16_f32 v36, v48, v49
    v_exp_f32 v51, v51
    v_exp_f32 v52, v52
    v_cvt_pk_bf16_f32 v37, v50, v51
    v_exp_f32 v53, v53
    v_mfma_f32_32x32x16_bf16 v[112:127], v[32:35], v[40:43], v[112:127]
    ds_read_b128 v[32:35], v3 offset:1536
    v_exp_f32 v54, v54
    v_cvt_pk_bf16_f32 v38, v52, v53
    v_exp_f32 v55, v55
    v_exp_f32 v56, v56
    v_cvt_pk_bf16_f32 v39, v54, v55
    v_exp_f32 v57, v57
    v_exp_f32 v58, v58
    v_mfma_f32_32x32x16_bf16 v[80:95], v[20:23], v[36:39], v[80:95]
    v_exp_f32 v59, v59
    v_cvt_pk_bf16_f32 v40, v56, v57
    v_exp_f32 v60, v60
    v_exp_f32 v61, v61
    v_cvt_pk_bf16_f32 v41, v58, v59
    v_exp_f32 v62, v62
    v_exp_f32 v63, v63
    v_cvt_pk_bf16_f32 v42, v60, v61
    v_cvt_pk_bf16_f32 v43, v62, v63
    v_mfma_f32_32x32x16_bf16 v[48:63], v[16:19], v[100:103], v[128:143]
    v_exp_f32 v64, v64
    v_exp_f32 v65, v65
    v_exp_f32 v66, v66
    v_cvt_pk_bf16_f32 v36, v64, v65
    v_exp_f32 v67, v67
    v_exp_f32 v68, v68
    v_cvt_pk_bf16_f32 v37, v66, v67
    v_exp_f32 v69, v69
    v_mfma_f32_32x32x16_bf16 v[80:95], v[24:27], v[40:43], v[80:95]
    v_exp_f32 v70, v70
    v_cvt_pk_bf16_f32 v38, v68, v69
    v_exp_f32 v71, v71
    v_exp_f32 v72, v72
    v_cvt_pk_bf16_f32 v39, v70, v71
    v_exp_f32 v73, v73
    v_exp_f32 v74, v74
    v_mfma_f32_32x32x16_bf16 v[112:127], v[20:23], v[36:39], v[112:127]
    v_exp_f32 v75, v75
    v_cvt_pk_bf16_f32 v40, v72, v73
    v_exp_f32 v76, v76
    v_exp_f32 v77, v77
    v_cvt_pk_bf16_f32 v41, v74, v75
    v_exp_f32 v78, v78
    v_exp_f32 v79, v79
    v_cvt_pk_bf16_f32 v42, v76, v77
    v_cvt_pk_bf16_f32 v43, v78, v79
    s_waitcnt lgkmcnt(0)
    v_mfma_f32_32x32x16_bf16 v[64:79], v[16:19], v[104:107], v[144:159]
    ds_read_b128 v[16:19], v2 offset:3072
    ds_read_b128 v[20:23], v3 offset:2048
    v_exp_f32 v48, v48
    v_exp_f32 v49, v49
    v_exp_f32 v50, v50
    v_cvt_pk_bf16_f32 v36, v48, v49
    v_exp_f32 v51, v51
    v_exp_f32 v52, v52
    v_cvt_pk_bf16_f32 v37, v50, v51
    v_exp_f32 v53, v53
    v_mfma_f32_32x32x16_bf16 v[112:127], v[24:27], v[40:43], v[112:127]
    ds_read_b128 v[24:27], v3 offset:2560
    v_exp_f32 v54, v54
    v_cvt_pk_bf16_f32 v38, v52, v53
    v_exp_f32 v55, v55
    v_exp_f32 v56, v56
    v_cvt_pk_bf16_f32 v39, v54, v55
    v_exp_f32 v57, v57
    v_exp_f32 v58, v58
    v_mfma_f32_32x32x16_bf16 v[80:95], v[28:31], v[36:39], v[80:95]
    v_exp_f32 v59, v59
    v_cvt_pk_bf16_f32 v40, v56, v57
    v_exp_f32 v60, v60
    v_exp_f32 v61, v61
    v_cvt_pk_bf16_f32 v41, v58, v59
    v_exp_f32 v62, v62
    v_exp_f32 v63, v63
    v_cvt_pk_bf16_f32 v42, v60, v61
    v_cvt_pk_bf16_f32 v43, v62, v63
    v_mfma_f32_32x32x16_bf16 v[48:63], v[12:15], v[100:103], v[128:143]
    v_exp_f32 v64, v64
    v_exp_f32 v65, v65
    v_exp_f32 v66, v66
    v_cvt_pk_bf16_f32 v36, v64, v65
    v_exp_f32 v67, v67
    v_exp_f32 v68, v68
    v_cvt_pk_bf16_f32 v37, v66, v67
    v_exp_f32 v69, v69
    v_mfma_f32_32x32x16_bf16 v[80:95], v[32:35], v[40:43], v[80:95]
    v_exp_f32 v70, v70
    v_cvt_pk_bf16_f32 v38, v68, v69
    v_exp_f32 v71, v71
    v_exp_f32 v72, v72
    v_cvt_pk_bf16_f32 v39, v70, v71
    v_exp_f32 v73, v73
    v_exp_f32 v74, v74
    v_mfma_f32_32x32x16_bf16 v[112:127], v[28:31], v[36:39], v[112:127]
    v_exp_f32 v75, v75
    v_cvt_pk_bf16_f32 v40, v72, v73
    v_exp_f32 v76, v76
    v_exp_f32 v77, v77
    v_cvt_pk_bf16_f32 v41, v74, v75
    v_exp_f32 v78, v78
    v_exp_f32 v79, v79
    v_cvt_pk_bf16_f32 v42, v76, v77
    v_cvt_pk_bf16_f32 v43, v78, v79
    s_waitcnt lgkmcnt(0)
    v_mfma_f32_32x32x16_bf16 v[64:79], v[12:15], v[104:107], v[144:159]
    ds_read_b128 v[12:15], v2 offset:4096
    ds_read_b128 v[28:31], v3 offset:3072
    buffer_load_dword v47, v46, s[20:23], s91 offen
    v_exp_f32 v48, v48
    v_exp_f32 v49, v49
    v_exp_f32 v50, v50
    v_cvt_pk_bf16_f32 v36, v48, v49
    v_exp_f32 v51, v51
    v_exp_f32 v52, v52
    v_cvt_pk_bf16_f32 v37, v50, v51
    v_exp_f32 v53, v53
    v_mfma_f32_32x32x16_bf16 v[112:127], v[32:35], v[40:43], v[112:127]
    ds_read_b128 v[32:35], v3 offset:3584
    v_exp_f32 v54, v54
    v_cvt_pk_bf16_f32 v38, v52, v53
    v_exp_f32 v55, v55
    v_exp_f32 v56, v56
    v_cvt_pk_bf16_f32 v39, v54, v55
    v_exp_f32 v57, v57
    v_exp_f32 v58, v58
    v_mfma_f32_32x32x16_bf16 v[80:95], v[20:23], v[36:39], v[80:95]
    v_exp_f32 v59, v59
    v_cvt_pk_bf16_f32 v40, v56, v57
    v_exp_f32 v60, v60
    v_exp_f32 v61, v61
    v_cvt_pk_bf16_f32 v41, v58, v59
    v_exp_f32 v62, v62
    v_exp_f32 v63, v63
    v_cvt_pk_bf16_f32 v42, v60, v61
    v_cvt_pk_bf16_f32 v43, v62, v63
    v_mfma_f32_32x32x16_bf16 v[48:63], v[16:19], v[100:103], v[128:143]
    v_exp_f32 v64, v64
    v_exp_f32 v65, v65
    v_exp_f32 v66, v66
    v_cvt_pk_bf16_f32 v36, v64, v65
    v_exp_f32 v67, v67
    v_exp_f32 v68, v68
    v_cvt_pk_bf16_f32 v37, v66, v67
    v_exp_f32 v69, v69
    v_mfma_f32_32x32x16_bf16 v[80:95], v[24:27], v[40:43], v[80:95]
    v_exp_f32 v70, v70
    v_cvt_pk_bf16_f32 v38, v68, v69
    v_exp_f32 v71, v71
    v_exp_f32 v72, v72
    v_cvt_pk_bf16_f32 v39, v70, v71
    v_exp_f32 v73, v73
    v_exp_f32 v74, v74
    v_mfma_f32_32x32x16_bf16 v[112:127], v[20:23], v[36:39], v[112:127]
    v_exp_f32 v75, v75
    v_cvt_pk_bf16_f32 v40, v72, v73
    v_exp_f32 v76, v76
    v_exp_f32 v77, v77
    v_cvt_pk_bf16_f32 v41, v74, v75
    v_exp_f32 v78, v78
    v_exp_f32 v79, v79
    v_cvt_pk_bf16_f32 v42, v76, v77
    v_cvt_pk_bf16_f32 v43, v78, v79
    s_waitcnt lgkmcnt(0)
    v_mfma_f32_32x32x16_bf16 v[64:79], v[16:19], v[104:107], v[144:159]
    ds_read_b128 v[16:19], v2 offset:5120
    ds_read_b128 v[20:23], v3 offset:4096
    v_exp_f32 v48, v48
    v_exp_f32 v49, v49
    v_exp_f32 v50, v50
    v_cvt_pk_bf16_f32 v36, v48, v49
    v_exp_f32 v51, v51
    v_exp_f32 v52, v52
    v_cvt_pk_bf16_f32 v37, v50, v51
    v_exp_f32 v53, v53
    v_mfma_f32_32x32x16_bf16 v[112:127], v[24:27], v[40:43], v[112:127]
    ds_read_b128 v[24:27], v3 offset:4608
    v_exp_f32 v54, v54
    v_cvt_pk_bf16_f32 v38, v52, v53
    v_exp_f32 v55, v55
    v_exp_f32 v56, v56
    v_cvt_pk_bf16_f32 v39, v54, v55
    v_exp_f32 v57, v57
    v_exp_f32 v58, v58
    v_mfma_f32_32x32x16_bf16 v[80:95], v[28:31], v[36:39], v[80:95]
    v_exp_f32 v59, v59
    v_cvt_pk_bf16_f32 v40, v56, v57
    v_exp_f32 v60, v60
    v_exp_f32 v61, v61
    v_cvt_pk_bf16_f32 v41, v58, v59
    v_exp_f32 v62, v62
    v_exp_f32 v63, v63
    v_cvt_pk_bf16_f32 v42, v60, v61
    v_cvt_pk_bf16_f32 v43, v62, v63
    v_mfma_f32_32x32x16_bf16 v[48:63], v[12:15], v[100:103], v[128:143]
    v_add_u32 v2, 4096, v2
    v_add_u32 v3, v4, v3
    v_exp_f32 v64, v64
    v_exp_f32 v65, v65
    v_exp_f32 v66, v66
    v_cvt_pk_bf16_f32 v36, v64, v65
    v_exp_f32 v67, v67
    v_exp_f32 v68, v68
    v_cvt_pk_bf16_f32 v37, v66, v67
    v_exp_f32 v69, v69
    v_mfma_f32_32x32x16_bf16 v[80:95], v[32:35], v[40:43], v[80:95]
    v_exp_f32 v70, v70
    v_cvt_pk_bf16_f32 v38, v68, v69
    v_exp_f32 v71, v71
    v_exp_f32 v72, v72
    v_cvt_pk_bf16_f32 v39, v70, v71
    v_exp_f32 v73, v73
    v_exp_f32 v74, v74
    v_mfma_f32_32x32x16_bf16 v[112:127], v[28:31], v[36:39], v[112:127]
    v_exp_f32 v75, v75
    v_cvt_pk_bf16_f32 v40, v72, v73
    v_exp_f32 v76, v76
    v_exp_f32 v77, v77
    v_cvt_pk_bf16_f32 v41, v74, v75
    v_exp_f32 v78, v78
    v_exp_f32 v79, v79
    v_cvt_pk_bf16_f32 v42, v76, v77
    v_cvt_pk_bf16_f32 v43, v78, v79
    s_sub_u32 s95, s95, 1
    s_cmp_lg_u32 s95, 0
    s_cbranch_scc1 K2_plain
    s_cmp_lg_u32 s96, 0
    s_cbranch_scc1 K2_done
    s_mov_b32 s94, 262144
    s_waitcnt vmcnt(0)
    s_mov_b64 exec, 1
    ds_add_u32 v45, v6
    s_mov_b64 exec, -1
K2_hwait:
    s_waitcnt vmcnt(0)
    v_cmp_ne_u32 vcc, s59, v47
    s_nop 4
    s_cbranch_vccz K2_hok
    s_sub_u32 s94, s94, 1
    s_cbranch_scc1 K2_iok
    s_sleep 2
    buffer_load_dword v47, v46, s[20:23], s91 offen sc1
    s_branch K2_hwait
K2_hok:
    v_xor_b32 v192, s59, v192
    v_xor_b32 v193, s59, v193
    v_xor_b32 v194, s59, v194
    v_xor_b32 v195, s59, v195
    v_or3_b32 v192, v192, v193, v194
    v_or_b32 v192, v192, v195
    v_cmp_ne_u32 vcc, 0, v192
    s_nop 4
    s_cbranch_vccz K2_iok
    s_sub_u32 s94, s94, 1
    s_cbranch_scc1 K2_iok
    s_sleep 8
    buffer_load_dwordx4 v[192:195], v10, s[20:23], s72 offen sc1
    s_waitcnt vmcnt(0)
    s_branch K2_hok
K2_iok:
    v_min_u32 v44, 7, v1
    v_lshlrev_b32 v44, 10, v44
    buffer_load_dwordx4 v[192:195], v10, s[20:23], s85 offen
    buffer_load_dwordx4 v[196:199], v10, s[20:23], s85 offen offset:1024
    s_add_u32 s85, s85, 16384
    buffer_load_dwordx4 v[200:203], v10, s[20:23], s84 offen offset:0
    buffer_load_dwordx4 v[204:207], v10, s[20:23], s85 offen
    buffer_load_dwordx4 v[208:211], v10, s[20:23], s85 offen offset:1024
    s_add_u32 s85, s85, 16384
    buffer_load_dwordx4 v[212:215], v10, s[20:23], s84 offen offset:1024
    buffer_load_dwordx4 v[216:219], v10, s[20:23], s85 offen
    buffer_load_dwordx4 v[220:223], v10, s[20:23], s85 offen offset:1024
    s_add_u32 s85, s85, 16384
    buffer_load_dwordx4 v[224:227], v10, s[20:23], s84 offen offset:2048
    buffer_load_dwordx4 v[228:231], v10, s[20:23], s85 offen
    buffer_load_dwordx4 v[232:235], v10, s[20:23], s85 offen offset:1024
    s_add_u32 s85, s85, 16384
    buffer_load_dwordx4 v[236:239], v10, s[20:23], s84 offen offset:3072
    s_add_u32 s84, s84, 4096
    buffer_load_dwordx4 v[240:243], v10, s[20:23], s85 offen
    buffer_load_dwordx4 v[244:247], v10, s[20:23], s85 offen offset:1024
    s_add_u32 s85, s85, 16384
    buffer_load_dwordx4 v[248:251], v10, s[20:23], s84 offen offset:0
    s_add_u32 s84, s84, 1024
    s_mov_b32 s95, 5
    s_xor_b32 s97, s3, 1
    s_mul_i32 s97, s97, 1
    s_mov_b32 s94, 2097152
    v_mov_b32 v109, 34816
K2_c2:
    ds_read_b32 v108, v109
    s_waitcnt lgkmcnt(0)
    v_readfirstlane_b32 s73, v108
    s_nop 0
    s_bitcmp1_b32 s73, 19
    s_cbranch_scc1 K2_c2_ok
    s_sleep 1
    s_sub_u32 s94, s94, 1
    s_cbranch_scc0 K2_c2
K2_c2_ok:
.p2align 6
K2_loop:
    s_waitcnt lgkmcnt(0)
    v_mfma_f32_32x32x16_bf16 v[64:79], v[12:15], v[104:107], v[144:159]
    ds_read_b128 v[12:15], v2 offset:2048
    ds_read_b128 v[28:31], v3 offset:1024
    s_cmp_lg_u32 s95, s97
    s_cbranch_scc1 K2_keep2
    s_setprio 0
K2_keep2:
    v_exp_f32 v48, v48
    v_exp_f32 v49, v49
    v_exp_f32 v50, v50
    v_cvt_pk_bf16_f32 v36, v48, v49
    v_exp_f32 v51, v51
    v_exp_f32 v52, v52
    v_mfma_f32_32x32x16_bf16 v[112:127], v[32:35], v[40:43], v[112:127]
    ds_read_b128 v[32:35], v3 offset:1536
    v_cvt_pk_bf16_f32 v37, v50, v51
    v_exp_f32 v53, v53
    v_exp_f32 v54, v54
    v_cvt_pk_bf16_f32 v38, v52, v53
    v_exp_f32 v55, v55
    v_exp_f32 v56, v56
    s_waitcnt vmcnt(12)
    v_mfma_f32_32x32x16_bf16 v[160:175], v[192:195], v[200:203], v[160:175]
    buffer_load_dwordx4 v[192:195], v10, s[20:23], s85 offen
    v_cvt_pk_bf16_f32 v39, v54, v55
    v_exp_f32 v57, v57
    v_exp_f32 v58, v58
    v_exp_f32 v59, v59
    v_cvt_pk_bf16_f32 v40, v56, v57
    v_mfma_f32_32x32x16_bf16 v[80:95], v[20:23], v[36:39], v[80:95]
    v_exp_f32 v60, v60
    v_exp_f32 v61, v61
    v_cvt_pk_bf16_f32 v41, v58, v59
    v_exp_f32 v62, v62
    v_exp_f32 v63, v63
    v_cvt_pk_bf16_f32 v42, v60, v61
    v_cvt_pk_bf16_f32 v43, v62, v63
    v_mfma_f32_32x32x16_bf16 v[48:63], v[16:19], v[100:103], v[128:143]
    v_exp_f32 v64, v64
    v_exp_f32 v65, v65
    v_exp_f32 v66, v66
    v_cvt_pk_bf16_f32 v36, v64, v65
    v_exp_f32 v67, v67
    v_exp_f32 v68, v68
    v_mfma_f32_32x32x16_bf16 v[80:95], v[24:27], v[40:43], v[80:95]
    v_cvt_pk_bf16_f32 v37, v66, v67
    v_exp_f32 v69, v69
    v_exp_f32 v70, v70
    v_cvt_pk_bf16_f32 v38, v68, v69
    v_exp_f32 v71, v71
    v_exp_f32 v72, v72
    v_mfma_f32_32x32x16_bf16 v[176:191], v[196:199], v[200:203], v[176:191]
    buffer_load_dwordx4 v[196:199], v10, s[20:23], s85 offen offset:1024
    s_add_u32 s85, s85, 16384
    buffer_load_dwordx4 v[200:203], v10, s[20:23], s84 offen offset:0
    v_cvt_pk_bf16_f32 v39, v70, v71
    v_exp_f32 v73, v73
    v_exp_f32 v74, v74
    v_exp_f32 v75, v75
    v_cvt_pk_bf16_f32 v40, v72, v73
    v_mfma_f32_32x32x16_bf16 v[112:127], v[20:23], v[36:39], v[112:127]
    v_exp_f32 v76, v76
    v_exp_f32 v77, v77
    v_cvt_pk_bf16_f32 v41, v74, v75
    v_exp_f32 v78, v78
    v_exp_f32 v79, v79
    v_cvt_pk_bf16_f32 v42, v76, v77
    v_cvt_pk_bf16_f32 v43, v78, v79
    s_waitcnt lgkmcnt(0)
    v_mfma_f32_32x32x16_bf16 v[64:79], v[16:19], v[104:107], v[144:159]
    ds_read_b128 v[16:19], v2 offset:3072
    ds_read_b128 v[20:23], v3 offset:2048
    v_exp_f32 v48, v48
    v_exp_f32 v49, v49
    v_exp_f32 v50, v50
    v_cvt_pk_bf16_f32 v36, v48, v49
    v_exp_f32 v51, v51
    v_exp_f32 v52, v52
    v_mfma_f32_32x32x16_bf16 v[112:127], v[24:27], v[40:43], v[112:127]
    ds_read_b128 v[24:27], v3 offset:2560
    v_cvt_pk_bf16_f32 v37, v50, v51
    v_exp_f32 v53, v53
    v_exp_f32 v54, v54
    v_cvt_pk_bf16_f32 v38, v52, v53
    v_exp_f32 v55, v55
    v_exp_f32 v56, v56
    s_waitcnt vmcnt(12)
    v_mfma_f32_32x32x16_bf16 v[160:175], v[204:207], v[212:215], v[160:175]
    buffer_load_dwordx4 v[204:207], v10, s[20:23], s85 offen
    v_cvt_pk_bf16_f32 v39, v54, v55
    v_exp_f32 v57, v57
    v_exp_f32 v58, v58
    v_exp_f32 v59, v59
    v_cvt_pk_bf16_f32 v40, v56, v57
    v_mfma_f32_32x32x16_bf16 v[80:95], v[28:31], v[36:39], v[80:95]
    v_exp_f32 v60, v60
    v_exp_f32 v61, v61
    v_cvt_pk_bf16_f32 v41, v58, v59
    v_exp_f32 v62, v62
    v_exp_f32 v63, v63
    v_cvt_pk_bf16_f32 v42, v60, v61
    v_cvt_pk_bf16_f32 v43, v62, v63
    v_mfma_f32_32x32x16_bf16 v[48:63], v[12:15], v[100:103], v[128:143]
    v_exp_f32 v64, v64
    v_exp_f32 v65, v65
    v_exp_f32 v66, v66
    v_cvt_pk_bf16_f32 v36, v64, v65
    v_exp_f32 v67, v67
    v_mfma_f32_32x32x16_bf16 v[80:95], v[32:35], v[40:43], v[80:95]
    v_exp_f32 v68, v68
    v_cvt_pk_bf16_f32 v37, v66, v67
    v_exp_f32 v69, v69
    v_exp_f32 v70, v70
    v_cvt_pk_bf16_f32 v38, v68, v69
    v_mfma_f32_32x32x16_bf16 v[176:191], v[208:211], v[212:215], v[176:191]
    buffer_load_dwordx4 v[208:211], v10, s[20:23], s85 offen offset:1024
    s_add_u32 s85, s85, 16384
    buffer_load_dwordx4 v[212:215], v10, s[20:23], s84 offen offset:1024
    v_exp_f32 v71, v71
    v_exp_f32 v72, v72
    v_cvt_pk_bf16_f32 v39, v70, v71
    v_exp_f32 v73, v73
    v_exp_f32 v74, v74
    v_mfma_f32_32x32x16_bf16 v[112:127], v[28:31], v[36:39], v[112:127]
    v_exp_f32 v75, v75
    v_cvt_pk_bf16_f32 v40, v72, v73
    v_exp_f32 v76, v76
    v_exp_f32 v77, v77
    v_cvt_pk_bf16_f32 v41, v74, v75
    s_waitcnt vmcnt(12)
    v_mfma_f32_32x32x16_bf16 v[160:175], v[216:219], v[224:227], v[160:175]
    buffer_load_dwordx4 v[216:219], v10, s[20:23], s85 offen
    v_exp_f32 v78, v78
    v_exp_f32 v79, v79
    v_cvt_pk_bf16_f32 v42, v76, v77
    v_cvt_pk_bf16_f32 v43, v78, v79
    s_waitcnt lgkmcnt(0)
    v_mfma_f32_32x32x16_bf16 v[64:79], v[12:15], v[104:107], v[144:159]
    ds_read_b128 v[12:15], v2 offset:4096
    ds_read_b128 v[28:31], v3 offset:3072
    v_exp_f32 v48, v48
    v_exp_f32 v49, v49
    v_exp_f32 v50, v50
    v_cvt_pk_bf16_f32 v36, v48, v49
    v_exp_f32 v51, v51
    v_exp_f32 v52, v52
    v_mfma_f32_32x32x16_bf16 v[112:127], v[32:35], v[40:43], v[112:127]
    ds_read_b128 v[32:35], v3 offset:3584
    v_cvt_pk_bf16_f32 v37, v50, v51
    v_exp_f32 v53, v53
    v_exp_f32 v54, v54
    v_cvt_pk_bf16_f32 v38, v52, v53
    v_exp_f32 v55, v55
    v_exp_f32 v56, v56
    v_mfma_f32_32x32x16_bf16 v[176:191], v[220:223], v[224:227], v[176:191]
    buffer_load_dwordx4 v[220:223], v10, s[20:23], s85 offen offset:1024
    s_add_u32 s85, s85, 16384
    buffer_load_dwordx4 v[224:227], v10, s[20:23], s84 offen offset:2048
    v_cvt_pk_bf16_f32 v39, v54, v55
    v_exp_f32 v57, v57
    v_exp_f32 v58, v58
    v_exp_f32 v59, v59
    v_cvt_pk_bf16_f32 v40, v56, v57
    v_mfma_f32_32x32x16_bf16 v[80:95], v[20:23], v[36:39], v[80:95]
    v_exp_f32 v60, v60
    v_exp_f32 v61, v61
    v_cvt_pk_bf16_f32 v41, v58, v59
    v_exp_f32 v62, v62
    v_exp_f32 v63, v63
    v_cvt_pk_bf16_f32 v42, v60, v61
    v_cvt_pk_bf16_f32 v43, v62, v63
    v_mfma_f32_32x32x16_bf16 v[48:63], v[16:19], v[100:103], v[128:143]
    v_exp_f32 v64, v64
    v_exp_f32 v65, v65
    v_exp_f32 v66, v66
    v_cvt_pk_bf16_f32 v36, v64, v65
    v_exp_f32 v67, v67
    v_exp_f32 v68, v68
    v_mfma_f32_32x32x16_bf16 v[80:95], v[24:27], v[40:43], v[80:95]
    v_cvt_pk_bf16_f32 v37, v66, v67
    v_exp_f32 v69, v69
    v_exp_f32 v70, v70
    v_cvt_pk_bf16_f32 v38, v68, v69
    v_exp_f32 v71, v71
    v_exp_f32 v72, v72
    s_waitcnt vmcnt(12)
    v_mfma_f32_32x32x16_bf16 v[160:175], v[228:231], v[236:239], v[160:175]
    buffer_load_dwordx4 v[228:231], v10, s[20:23], s85 offen
    v_cvt_pk_bf16_f32 v39, v70, v71
    v_exp_f32 v73, v73
    v_exp_f32 v74, v74
    v_exp_f32 v75, v75
    v_cvt_pk_bf16_f32 v40, v72, v73
    v_mfma_f32_32x32x16_bf16 v[112:127], v[20:23], v[36:39], v[112:127]
    v_exp_f32 v76, v76
    v_exp_f32 v77, v77
    v_cvt_pk_bf16_f32 v41, v74, v75
    v_exp_f32 v78, v78
    v_exp_f32 v79, v79
    v_cvt_pk_bf16_f32 v42, v76, v77
    v_cvt_pk_bf16_f32 v43, v78, v79
    s_waitcnt lgkmcnt(0)
    v_mfma_f32_32x32x16_bf16 v[64:79], v[16:19], v[104:107], v[144:159]
    ds_read_b128 v[16:19], v2 offset:5120
    ds_read_b128 v[20:23], v3 offset:4096
    v_exp_f32 v48, v48
    v_exp_f32 v49, v49
    v_exp_f32 v50, v50
    v_cvt_pk_bf16_f32 v36, v48, v49
    v_exp_f32 v51, v51
    v_exp_f32 v52, v52
    v_mfma_f32_32x32x16_bf16 v[112:127], v[24:27], v[40:43], v[112:127]
    ds_read_b128 v[24:27], v3 offset:4608
    v_cvt_pk_bf16_f32 v37, v50, v51
    v_exp_f32 v53, v53
    v_exp_f32 v54, v54
    v_cvt_pk_bf16_f32 v38, v52, v53
    v_exp_f32 v55, v55
    v_exp_f32 v56, v56
    v_mfma_f32_32x32x16_bf16 v[176:191], v[232:235], v[236:239], v[176:191]
    buffer_load_dwordx4 v[232:235], v10, s[20:23], s85 offen offset:1024
    s_add_u32 s85, s85, 16384
    buffer_load_dwordx4 v[236:239], v10, s[20:23], s84 offen offset:3072
    s_add_u32 s84, s84, 4096
    v_cvt_pk_bf16_f32 v39, v54, v55
    v_exp_f32 v57, v57
    v_exp_f32 v58, v58
    v_exp_f32 v59, v59
    v_cvt_pk_bf16_f32 v40, v56, v57
    v_mfma_f32_32x32x16_bf16 v[80:95], v[28:31], v[36:39], v[80:95]
    v_exp_f32 v60, v60
    v_exp_f32 v61, v61
    v_cvt_pk_bf16_f32 v41, v58, v59
    v_exp_f32 v62, v62
    v_exp_f32 v63, v63
    v_cvt_pk_bf16_f32 v42, v60, v61
    v_cvt_pk_bf16_f32 v43, v62, v63
    v_mfma_f32_32x32x16_bf16 v[48:63], v[12:15], v[100:103], v[128:143]
    v_add_u32 v2, 4096, v2
    v_add_u32 v3, v4, v3
    v_exp_f32 v64, v64
    v_exp_f32 v65, v65
    v_exp_f32 v66, v66
    v_cvt_pk_bf16_f32 v36, v64, v65
    v_exp_f32 v67, v67
    v_mfma_f32_32x32x16_bf16 v[80:95], v[32:35], v[40:43], v[80:95]
    v_exp_f32 v68, v68
    v_cvt_pk_bf16_f32 v37, v66, v67
    v_exp_f32 v69, v69
    v_exp_f32 v70, v70
    v_cvt_pk_bf16_f32 v38, v68, v69
    s_waitcnt vmcnt(12)
    v_mfma_f32_32x32x16_bf16 v[160:175], v[240:243], v[248:251], v[160:175]
    buffer_load_dwordx4 v[240:243], v10, s[20:23], s85 offen
    v_exp_f32 v71, v71
    v_exp_f32 v72, v72
    v_cvt_pk_bf16_f32 v39, v70, v71
    v_exp_f32 v73, v73
    v_exp_f32 v74, v74
    v_mfma_f32_32x32x16_bf16 v[112:127], v[28:31], v[36:39], v[112:127]
    v_exp_f32 v75, v75
    v_cvt_pk_bf16_f32 v40, v72, v73
    v_exp_f32 v76, v76
    v_exp_f32 v77, v77
    v_cvt_pk_bf16_f32 v41, v74, v75
    v_mfma_f32_32x32x16_bf16 v[176:191], v[244:247], v[248:251], v[176:191]
    buffer_load_dwordx4 v[244:247], v10, s[20:23], s85 offen offset:1024
    s_add_u32 s85, s85, 16384
    buffer_load_dwordx4 v[248:251], v10, s[20:23], s84 offen offset:0
    s_add_u32 s84, s84, 1024
    v_exp_f32 v78, v78
    v_exp_f32 v79, v79
    v_cvt_pk_bf16_f32 v42, v76, v77
    v_cvt_pk_bf16_f32 v43, v78, v79
    s_sub_u32 s95, s95, 1
    s_cmp_eq_u32 s95, 2
    s_cbranch_scc1 K2_c3in
    s_cmp_lg_u32 s95, 0
    s_cbranch_scc1 K2_loop
    s_waitcnt lgkmcnt(0)
    v_mfma_f32_32x32x16_bf16 v[64:79], v[12:15], v[104:107], v[144:159]
    ds_read_b128 v[12:15], v2 offset:2048
    ds_read_b128 v[28:31], v3 offset:1024
    s_cmp_ge_u32 s32, 4
    s_cbranch_scc1 K2_keep
    s_setprio 0
K2_keep:
    v_exp_f32 v48, v48
    v_exp_f32 v49, v49
    v_exp_f32 v50, v50
    v_cvt_pk_bf16_f32 v36, v48, v49
    v_exp_f32 v51, v51
    v_exp_f32 v52, v52
    v_mfma_f32_32x32x16_bf16 v[112:127], v[32:35], v[40:43], v[112:127]
    ds_read_b128 v[32:35], v3 offset:1536
    v_cvt_pk_bf16_f32 v37, v50, v51
    v_exp_f32 v53, v53
    v_exp_f32 v54, v54
    v_cvt_pk_bf16_f32 v38, v52, v53
    v_exp_f32 v55, v55
    v_exp_f32 v56, v56
    s_waitcnt vmcnt(12)
    v_mfma_f32_32x32x16_bf16 v[160:175], v[192:195], v[200:203], v[160:175]
    buffer_load_dwordx4 v[228:231], v10, s[20:23], s86 offen offset:0
    buffer_load_dwordx4 v[232:235], v10, s[20:23], s86 offen offset:1024
    s_add_u32 s86, s86, 16384
    v_cvt_pk_bf16_f32 v39, v54, v55
    v_exp_f32 v57, v57
    v_exp_f32 v58, v58
    v_exp_f32 v59, v59
    v_cvt_pk_bf16_f32 v40, v56, v57
    v_mfma_f32_32x32x16_bf16 v[80:95], v[20:23], v[36:39], v[80:95]
    v_exp_f32 v60, v60
    v_exp_f32 v61, v61
    v_cvt_pk_bf16_f32 v41, v58, v59
    v_exp_f32 v62, v62
    v_exp_f32 v63, v63
    v_cvt_pk_bf16_f32 v42, v60, v61
    v_cvt_pk_bf16_f32 v43, v62, v63
    v_mfma_f32_32x32x16_bf16 v[48:63], v[16:19], v[100:103], v[128:143]
    v_exp_f32 v64, v64
    v_exp_f32 v65, v65
    v_exp_f32 v66, v66
    v_cvt_pk_bf16_f32 v36, v64, v65
    v_exp_f32 v67, v67
    v_exp_f32 v68, v68
    v_mfma_f32_32x32x16_bf16 v[80:95], v[24:27], v[40:43], v[80:95]
    v_cvt_pk_bf16_f32 v37, v66, v67
    v_exp_f32 v69, v69
    v_exp_f32 v70, v70
    v_cvt_pk_bf16_f32 v38, v68, v69
    v_exp_f32 v71, v71
    v_exp_f32 v72, v72
    v_mfma_f32_32x32x16_bf16 v[176:191], v[196:199], v[200:203], v[176:191]
    buffer_load_dwordx4 v[236:239], v10, s[20:23], s86 offen offset:0
    buffer_load_dwordx4 v[240:243], v10, s[20:23], s86 offen offset:1024
    s_add_u32 s86, s86, 16384
    v_cvt_pk_bf16_f32 v39, v70, v71
    v_exp_f32 v73, v73
    v_exp_f32 v74, v74
    v_exp_f32 v75, v75
    v_cvt_pk_bf16_f32 v40, v72, v73
    v_mfma_f32_32x32x16_bf16 v[112:127], v[20:23], v[36:39], v[112:127]
    v_exp_f32 v76, v76
    v_exp_f32 v77, v77
    v_cvt_pk_bf16_f32 v41, v74, v75
    v_exp_f32 v78, v78
    v_exp_f32 v79, v79
    v_cvt_pk_bf16_f32 v42, v76, v77
    v_cvt_pk_bf16_f32 v43, v78, v79
    s_waitcnt lgkmcnt(0)
    v_mfma_f32_32x32x16_bf16 v[64:79], v[16:19], v[104:107], v[144:159]
    ds_read_b128 v[16:19], v2 offset:3072
    ds_read_b128 v[20:23], v3 offset:2048
    v_exp_f32 v48, v48
    v_exp_f32 v49, v49
    v_exp_f32 v50, v50
    v_cvt_pk_bf16_f32 v36, v48, v49
    v_exp_f32 v51, v51
    v_exp_f32 v52, v52
    v_mfma_f32_32x32x16_bf16 v[112:127], v[24:27], v[40:43], v[112:127]
    ds_read_b128 v[24:27], v3 offset:2560
    v_cvt_pk_bf16_f32 v37, v50, v51
    v_exp_f32 v53, v53
    v_exp_f32 v54, v54
    v_cvt_pk_bf16_f32 v38, v52, v53
    v_exp_f32 v55, v55
    v_exp_f32 v56, v56
    s_waitcnt vmcnt(13)
    v_mfma_f32_32x32x16_bf16 v[160:175], v[204:207], v[212:215], v[160:175]
    buffer_load_dwordx4 v[244:247], v10, s[20:23], s86 offen offset:0
    buffer_load_dwordx4 v[248:251], v10, s[20:23], s86 offen offset:1024
    s_add_u32 s86, s86, 16384
    buffer_load_dwordx4 v[252:255], v10, s[20:23], s86 offen offset:0
    v_cvt_pk_bf16_f32 v39, v54, v55
    v_exp_f32 v57, v57
    v_exp_f32 v58, v58
    v_exp_f32 v59, v59
    v_cvt_pk_bf16_f32 v40, v56, v57
    v_mfma_f32_32x32x16_bf16 v[80:95], v[28:31], v[36:39], v[80:95]
    v_exp_f32 v60, v60
    v_exp_f32 v61, v61
    v_cvt_pk_bf16_f32 v41, v58, v59
    v_exp_f32 v62, v62
    v_exp_f32 v63, v63
    v_cvt_pk_bf16_f32 v42, v60, v61
    v_cvt_pk_bf16_f32 v43, v62, v63
    v_mfma_f32_32x32x16_bf16 v[48:63], v[12:15], v[100:103], v[128:143]
    v_exp_f32 v64, v64
    v_exp_f32 v65, v65
    v_exp_f32 v66, v66
    v_cvt_pk_bf16_f32 v36, v64, v65
    v_exp_f32 v67, v67
    v_exp_f32 v68, v68
    v_mfma_f32_32x32x16_bf16 v[80:95], v[32:35], v[40:43], v[80:95]
    v_cvt_pk_bf16_f32 v37, v66, v67
    v_exp_f32 v69, v69
    v_exp_f32 v70, v70
    v_cvt_pk_bf16_f32 v38, v68, v69
    v_exp_f32 v71, v71
    v_exp_f32 v72, v72
    v_mfma_f32_32x32x16_bf16 v[176:191], v[208:211], v[212:215], v[176:191]
    buffer_load_dwordx4 v[192:195], v10, s[20:23], s86 offen offset:1024
    s_add_u32 s86, s86, 16384
    buffer_load_dwordx4 v[196:199], v10, s[20:23], s86 offen offset:0
    buffer_load_dwordx4 v[200:203], v10, s[20:23], s86 offen offset:1024
    s_add_u32 s86, s86, 16384
    v_cvt_pk_bf16_f32 v39, v70, v71
    v_exp_f32 v73, v73
    v_exp_f32 v74, v74
    v_exp_f32 v75, v75
    v_cvt_pk_bf16_f32 v40, v72, v73
    v_mfma_f32_32x32x16_bf16 v[112:127], v[28:31], v[36:39], v[112:127]
    v_exp_f32 v76, v76
    v_exp_f32 v77, v77
    v_cvt_pk_bf16_f32 v41, v74, v75
    v_exp_f32 v78, v78
    v_exp_f32 v79, v79
    v_cvt_pk_bf16_f32 v42, v76, v77
    v_cvt_pk_bf16_f32 v43, v78, v79
    s_waitcnt lgkmcnt(0)
    v_mfma_f32_32x32x16_bf16 v[64:79], v[12:15], v[104:107], v[144:159]
    ds_read_b128 v[12:15], v2 offset:4096
    ds_read_b128 v[28:31], v3 offset:3072
    v_exp_f32 v48, v48
    v_exp_f32 v49, v49
    v_exp_f32 v50, v50
    v_cvt_pk_bf16_f32 v36, v48, v49
    v_exp_f32 v51, v51
    v_exp_f32 v52, v52
    v_mfma_f32_32x32x16_bf16 v[112:127], v[32:35], v[40:43], v[112:127]
    ds_read_b128 v[32:35], v3 offset:3584
    v_cvt_pk_bf16_f32 v37, v50, v51
    v_exp_f32 v53, v53
    v_exp_f32 v54, v54
    v_cvt_pk_bf16_f32 v38, v52, v53
    v_exp_f32 v55, v55
    v_exp_f32 v56, v56
    s_waitcnt vmcnt(16)
    v_mfma_f32_32x32x16_bf16 v[160:175], v[216:219], v[224:227], v[160:175]
    buffer_load_dwordx4 v[204:207], v10, s[20:23], s86 offen offset:0
    buffer_load_dwordx4 v[208:211], v10, s[20:23], s86 offen offset:1024
    s_add_u32 s86, s86, 16384
    buffer_load_dwordx4 v[212:215], v10, s[20:23], s86 offen offset:0
    v_cvt_pk_bf16_f32 v39, v54, v55
    v_exp_f32 v57, v57
    v_exp_f32 v58, v58
    v_exp_f32 v59, v59
    v_cvt_pk_bf16_f32 v40, v56, v57
    v_mfma_f32_32x32x16_bf16 v[80:95], v[20:23], v[36:39], v[80:95]
    v_exp_f32 v60, v60
    v_exp_f32 v61, v61
    v_cvt_pk_bf16_f32 v41, v58, v59
    v_exp_f32 v62, v62
    v_exp_f32 v63, v63
    v_cvt_pk_bf16_f32 v42, v60, v61
    v_cvt_pk_bf16_f32 v43, v62, v63
    v_mfma_f32_32x32x16_bf16 v[48:63], v[16:19], v[100:103], v[128:143]
    v_exp_f32 v64, v64
    v_exp_f32 v65, v65
    v_exp_f32 v66, v66
    v_cvt_pk_bf16_f32 v36, v64, v65
    v_exp_f32 v67, v67
    v_exp_f32 v68, v68
    v_mfma_f32_32x32x16_bf16 v[80:95], v[24:27], v[40:43], v[80:95]
    v_cvt_pk_bf16_f32 v37, v66, v67
    v_exp_f32 v69, v69
    v_exp_f32 v70, v70
    v_cvt_pk_bf16_f32 v38, v68, v69
    v_exp_f32 v71, v71
    v_exp_f32 v72, v72
    v_mfma_f32_32x32x16_bf16 v[176:191], v[220:223], v[224:227], v[176:191]
    buffer_load_dwordx4 v[216:219], v10, s[20:23], s86 offen offset:1024
    s_add_u32 s86, s86, 16384
    buffer_load_dwordx4 v[220:223], v10, s[20:23], s86 offen offset:0
    buffer_load_dwordx4 v[224:227], v10, s[20:23], s86 offen offset:1024
    s_add_u32 s86, s86, 16384
    v_cvt_pk_bf16_f32 v39, v70, v71
    v_exp_f32 v73, v73
    v_exp_f32 v74, v74
    v_exp_f32 v75, v75
    v_cvt_pk_bf16_f32 v40, v72, v73
    v_mfma_f32_32x32x16_bf16 v[112:127], v[20:23], v[36:39], v[112:127]
    v_exp_f32 v76, v76
    v_exp_f32 v77, v77
    v_cvt_pk_bf16_f32 v41, v74, v75
    v_exp_f32 v78, v78
    v_exp_f32 v79, v79
    v_cvt_pk_bf16_f32 v42, v76, v77
    v_cvt_pk_bf16_f32 v43, v78, v79
    s_waitcnt lgkmcnt(0)
    v_mfma_f32_32x32x16_bf16 v[64:79], v[16:19], v[104:107], v[144:159]
    ds_read_b128 v[16:19], v2 offset:5120
    ds_read_b128 v[20:23], v3 offset:4096
    v_exp_f32 v48, v48
    v_exp_f32 v49, v49
    v_exp_f32 v50, v50
    v_cvt_pk_bf16_f32 v36, v48, v49
    v_exp_f32 v51, v51
    v_exp_f32 v52, v52
    v_cvt_pk_bf16_f32 v37, v50, v51
    v_exp_f32 v53, v53
    v_mfma_f32_32x32x16_bf16 v[112:127], v[24:27], v[40:43], v[112:127]
    ds_read_b128 v[24:27], v3 offset:4608
    v_exp_f32 v54, v54
    v_cvt_pk_bf16_f32 v38, v52, v53
    v_exp_f32 v55, v55
    v_exp_f32 v56, v56
    v_cvt_pk_bf16_f32 v39, v54, v55
    v_exp_f32 v57, v57
    v_exp_f32 v58, v58
    v_mfma_f32_32x32x16_bf16 v[80:95], v[28:31], v[36:39], v[80:95]
    v_exp_f32 v59, v59
    v_cvt_pk_bf16_f32 v40, v56, v57
    v_exp_f32 v60, v60
    v_exp_f32 v61, v61
    v_cvt_pk_bf16_f32 v41, v58, v59
    v_exp_f32 v62, v62
    v_exp_f32 v63, v63
    v_cvt_pk_bf16_f32 v42, v60, v61
    v_cvt_pk_bf16_f32 v43, v62, v63
    s_nop 0
    v_add_u32 v2, 4096, v2
    v_add_u32 v3, v4, v3
    v_exp_f32 v64, v64
    v_exp_f32 v65, v65
    v_exp_f32 v66, v66
    v_cvt_pk_bf16_f32 v36, v64, v65
    v_exp_f32 v67, v67
    v_exp_f32 v68, v68
    v_mfma_f32_32x32x16_bf16 v[80:95], v[32:35], v[40:43], v[80:95]
    v_cvt_pk_bf16_f32 v37, v66, v67
    v_exp_f32 v69, v69
    v_exp_f32 v70, v70
    v_cvt_pk_bf16_f32 v38, v68, v69
    v_exp_f32 v71, v71
    v_exp_f32 v72, v72
    buffer_load_dword v45, v44, s[20:23], s87 offen offset:1020 sc1
    v_cvt_pk_bf16_f32 v39, v70, v71
    v_exp_f32 v73, v73
    v_exp_f32 v74, v74
    v_exp_f32 v75, v75
    v_cvt_pk_bf16_f32 v40, v72, v73
    v_mfma_f32_32x32x16_bf16 v[112:127], v[28:31], v[36:39], v[112:127]
    v_exp_f32 v76, v76
    v_exp_f32 v77, v77
    v_cvt_pk_bf16_f32 v41, v74, v75
    v_exp_f32 v78, v78
    v_exp_f32 v79, v79
    v_cvt_pk_bf16_f32 v42, v76, v77
    v_cvt_pk_bf16_f32 v43, v78, v79
K2_done:
    s_nop 1
    v_mfma_f32_32x32x16_bf16 v[112:127], v[32:35], v[40:43], v[112:127]
    v_mov_b32 v108, v88
    v_fma_f32 v108, v80, 0, v108
    v_fma_f32 v108, v81, 0, v108
    v_fma_f32 v108, v82, 0, v108
    v_fma_f32 v108, v83, 0, v108
    v_fma_f32 v108, v84, 0, v108
    v_fma_f32 v108, v85, 0, v108
    v_fma_f32 v108, v86, 0, v108
    v_fma_f32 v108, v87, 0, v108
    v_mov_b32 v109, 0x5d800000
    v_lshlrev_b32 v8, 3, v1
    v_add_u32 v9, s93, v8
    v_add_u32 v8, s92, v8
    v_cmp_nlt_f32 s[98:99], v108, v109
    v_mov_b32 v110, v120
    v_fma_f32 v110, v112, 0, v110
    v_fma_f32 v110, v113, 0, v110
    v_fma_f32 v110, v114, 0, v110
    v_fma_f32 v110, v115, 0, v110
    v_fma_f32 v110, v116, 0, v110
    v_fma_f32 v110, v117, 0, v110
    v_fma_f32 v110, v118, 0, v110
    v_fma_f32 v110, v119, 0, v110
    v_cmp_nlt_f32 vcc, v110, v109
    v_add_u32 v108, s92, v10
    v_add_u32 v109, s93, v10
    s_or_b64 vcc, vcc, s[98:99]
    s_cmp_lg_u32 s96, 0
    s_cbranch_scc1 K2_fine
    s_cbranch_vccnz K2_fallback
K2_fine:
    s_setprio 0
    s_cmp_ge_u32 s32, 4
    s_cbranch_scc1 K2_finB
    v_mov_b32 v121, v144
    ds_write_b128 v108, v[112:115]
    ds_write_b128 v108, v[116:119] offset:1024
    ds_write_b64 v8, v[120:121] offset:2048
    s_waitcnt lgkmcnt(0)
    s_barrier
    ds_read_b64 v[72:73], v9 offset:2048
    ds_read_b128 v[64:67], v109
    ds_read_b128 v[68:71], v109 offset:1024
    s_waitcnt lgkmcnt(2)
    v_min_f32 v74, v128, v73
    v_sub_f32 v75, v74, v128
    v_sub_f32 v76, v74, v73
    v_exp_f32 v75, v75
    v_exp_f32 v76, v76
    v_mul_f32 v77, v88, v75
    v_fma_f32 v77, v72, v76, v77
    v_rcp_f32 v77, v77
    s_nop 0
    v_mul_f32 v75, v75, v77
    v_mul_f32 v76, v76, v77
    s_waitcnt lgkmcnt(0)
    v_mul_f32 v80, v80, v75
    v_mul_f32 v81, v81, v75
    v_mul_f32 v82, v82, v75
    v_mul_f32 v83, v83, v75
    v_mul_f32 v84, v84, v75
    v_mul_f32 v85, v85, v75
    v_mul_f32 v86, v86, v75
    v_mul_f32 v87, v87, v75
    v_fma_f32 v80, v64, v76, v80
    v_fma_f32 v81, v65, v76, v81
    v_fma_f32 v82, v66, v76, v82
    v_fma_f32 v83, v67, v76, v83
    v_fma_f32 v84, v68, v76, v84
    v_fma_f32 v85, v69, v76, v85
    v_fma_f32 v86, v70, v76, v86
    v_fma_f32 v87, v71, v76, v87
    v_cvt_pk_bf16_f32 v36, v80, v81
    v_cvt_pk_bf16_f32 v37, v82, v83
    v_cvt_pk_bf16_f32 v38, v84, v85
    v_cvt_pk_bf16_f32 v39, v86, v87
    s_branch K2_tail
K2_finB:
    v_mov_b32 v89, v128
    ds_write_b128 v108, v[80:83]
    ds_write_b128 v108, v[84:87] offset:1024
    ds_write_b64 v8, v[88:89] offset:2048
    s_waitcnt lgkmcnt(0)
    s_barrier
    ds_read_b64 v[72:73], v9 offset:2048
    ds_read_b128 v[64:67], v109
    ds_read_b128 v[68:71], v109 offset:1024
    s_waitcnt lgkmcnt(2)
    v_min_f32 v74, v144, v73
    v_sub_f32 v75, v74, v144
    v_sub_f32 v76, v74, v73
    v_exp_f32 v75, v75
    v_exp_f32 v76, v76
    v_mul_f32 v77, v120, v75
    v_fma_f32 v77, v72, v76, v77
    v_rcp_f32 v77, v77
    s_nop 0
    v_mul_f32 v75, v75, v77
    v_mul_f32 v76, v76, v77
    s_waitcnt lgkmcnt(0)
    v_mul_f32 v112, v112, v75
    v_mul_f32 v113, v113, v75
    v_mul_f32 v114, v114, v75
    v_mul_f32 v115, v115, v75
    v_mul_f32 v116, v116, v75
    v_mul_f32 v117, v117, v75
    v_mul_f32 v118, v118, v75
    v_mul_f32 v119, v119, v75
    v_fma_f32 v112, v64, v76, v112
    v_fma_f32 v113, v65, v76, v113
    v_fma_f32 v114, v66, v76, v114
    v_fma_f32 v115, v67, v76, v115
    v_fma_f32 v116, v68, v76, v116
    v_fma_f32 v117, v69, v76, v117
    v_fma_f32 v118, v70, v76, v118
    v_fma_f32 v119, v71, v76, v119
    v_cvt_pk_bf16_f32 v36, v112, v113
    v_cvt_pk_bf16_f32 v37, v114, v115
    v_cvt_pk_bf16_f32 v38, v116, v117
    v_cvt_pk_bf16_f32 v39, v118, v119
K2_tail:
    v_min_u32 v36, -2, v36
    v_min_u32 v37, -2, v37
    v_min_u32 v38, -2, v38
    v_min_u32 v39, -2, v39
    buffer_store_dwordx4 v[36:39], v10, s[20:23], s56 offen sc1
    s_mov_b32 s94, 262144
    s_mov_b32 s97, 0
    s_waitcnt vmcnt(1)
    s_barrier
K2_round:
    v_cmp_eq_u32 vcc, -1, v45
    s_bitcmp1_b32 s97, 0
    s_cbranch_scc1 K2_ri0
    s_bfe_u32 s72, vcc_lo, 0x40000
    s_bcnt1_i32_b32 s72, s72
    s_cmp_gt_u32 s72, 4
    s_cbranch_scc1 K2_ri0
    s_bitset1_b32 s97, 2
    s_bfe_u32 s73, s97, 0x10004
    s_or_b32 s72, s72, s73
    s_cbranch_scc1 K2_rs0
    buffer_load_dwordx4 v[48:51], v10, s[20:23], s87 offen offset:0
    buffer_load_dwordx4 v[52:55], v10, s[20:23], s87 offen offset:1024
    buffer_load_dwordx4 v[56:59], v10, s[20:23], s87 offen offset:2048
    buffer_load_dwordx4 v[60:63], v10, s[20:23], s87 offen offset:3072
K2_ri0:
    s_bitcmp1_b32 s97, 1
    s_cbranch_scc1 K2_ri1
    s_bfe_u32 s72, vcc_lo, 0x40004
    s_bcnt1_i32_b32 s72, s72
    s_cmp_gt_u32 s72, 4
    s_cbranch_scc1 K2_ri1
    s_bitset1_b32 s97, 3
    s_bfe_u32 s73, s97, 0x10005
    s_or_b32 s72, s72, s73
    s_cbranch_scc1 K2_rs1
    buffer_load_dwordx4 v[12:15], v10, s[20:23], s88 offen offset:0
    buffer_load_dwordx4 v[16:19], v10, s[20:23], s88 offen offset:1024
    buffer_load_dwordx4 v[20:23], v10, s[20:23], s88 offen offset:2048
    buffer_load_dwordx4 v[24:27], v10, s[20:23], s88 offen offset:3072
K2_ri1:
    s_lshr_b32 s72, s97, 2
    s_or_b32 s72, s72, s97
    s_and_b32 s72, s72, 3
    s_cmp_eq_u32 s72, 3
    s_cbranch_scc1 K2_rnp
    buffer_load_dword v45, v44, s[20:23], s87 offen offset:1020 sc1
K2_rnp:
    s_cmp_lg_u32 s94, 262144
    s_cbranch_scc1 K2_rw
    v_and_b32 v110, 31, v1
    v_mul_u32_u24 v110, 272, v110
    v_lshrrev_b32 v111, 5, v1
    v_lshl_add_u32 v110, v111, 4, v110
    v_add_u32 v110, s90, v110
    v_lshrrev_b32 v111, 3, v0
    v_mul_u32_u24 v111, 272, v111
    v_and_b32 v46, 7, v0
    v_lshl_add_u32 v111, v46, 4, v111
    v_lshlrev_b32 v128, 16, v96
    v_and_b32 v132, 0xffff0000, v96
    v_lshlrev_b32 v129, 16, v97
    v_and_b32 v133, 0xffff0000, v97
    v_lshlrev_b32 v130, 16, v98
    v_and_b32 v134, 0xffff0000, v98
    v_lshlrev_b32 v131, 16, v99
    v_and_b32 v135, 0xffff0000, v99
K2_rw:
    s_waitcnt vmcnt(0)
    s_bitcmp0_b32 s97, 2
    s_cbranch_scc1 K2_rv0
    v_max3_u32 v108, v48, v49, v50
    v_max3_u32 v109, v51, v52, v53
    v_max3_u32 v108, v108, v54, v55
    v_max3_u32 v109, v109, v56, v57
    v_max3_u32 v108, v108, v58, v59
    v_max3_u32 v109, v109, v60, v61
    v_max3_u32 v108, v108, v62, v63
    v_max_u32 v108, v108, v109
    v_cmp_eq_u32 vcc, -1, v108
    s_bitset0_b32 s97, 2
    s_bitset1_b32 s97, 4
    s_nop 2
    s_cbranch_vccnz K2_rv0
    s_bitset1_b32 s97, 0
    v_mfma_f32_32x32x16_bf16 v[160:175], v[228:231], v[48:51], v[160:175]
    v_mfma_f32_32x32x16_bf16 v[176:191], v[232:235], v[48:51], v[176:191]
    v_mfma_f32_32x32x16_bf16 v[160:175], v[236:239], v[52:55], v[160:175]
    v_mfma_f32_32x32x16_bf16 v[176:191], v[240:243], v[52:55], v[176:191]
    v_mfma_f32_32x32x16_bf16 v[160:175], v[244:247], v[56:59], v[160:175]
    v_mfma_f32_32x32x16_bf16 v[176:191], v[248:251], v[56:59], v[176:191]
    v_mfma_f32_32x32x16_bf16 v[160:175], v[252:255], v[60:63], v[160:175]
    v_mfma_f32_32x32x16_bf16 v[176:191], v[192:195], v[60:63], v[176:191]
K2_rv0:
    s_bitcmp0_b32 s97, 3
    s_cbranch_scc1 K2_rv1
    v_max3_u32 v108, v12, v13, v14
    v_max3_u32 v109, v15, v16, v17
    v_max3_u32 v108, v108, v18, v19
    v_max3_u32 v109, v109, v20, v21
    v_max3_u32 v108, v108, v22, v23
    v_max3_u32 v109, v109, v24, v25
    v_max3_u32 v108, v108, v26, v27
    v_max_u32 v108, v108, v109
    v_cmp_eq_u32 vcc, -1, v108
    s_bitset0_b32 s97, 3
    s_bitset1_b32 s97, 5
    s_nop 2
    s_cbranch_vccnz K2_rv1
    s_bitset1_b32 s97, 1
    v_mfma_f32_32x32x16_bf16 v[80:95], v[196:199], v[12:15], 0
    v_mfma_f32_32x32x16_bf16 v[112:127], v[200:203], v[12:15], 0
    v_mfma_f32_32x32x16_bf16 v[80:95], v[204:207], v[16:19], v[80:95]
    v_mfma_f32_32x32x16_bf16 v[112:127], v[208:211], v[16:19], v[112:127]
    v_mfma_f32_32x32x16_bf16 v[80:95], v[212:215], v[20:23], v[80:95]
    v_mfma_f32_32x32x16_bf16 v[112:127], v[216:219], v[20:23], v[112:127]
    v_mfma_f32_32x32x16_bf16 v[80:95], v[220:223], v[24:27], v[80:95]
    v_mfma_f32_32x32x16_bf16 v[112:127], v[224:227], v[24:27], v[112:127]
K2_rv1:
    s_and_b32 s72, s97, 3
    s_cmp_eq_u32 s72, 3
    s_cbranch_scc1 K2_odone
    s_sub_u32 s94, s94, 1
    s_cbranch_scc0 K2_round
K2_odone:
    s_nop 7
    v_add_f32 v160, v160, v80
    v_add_f32 v161, v161, v81
    v_add_f32 v162, v162, v82
    v_add_f32 v163, v163, v83
    ds_write_b128 v110, v[160:163] offset:0
    v_add_f32 v164, v164, v84
    v_add_f32 v165, v165, v85
    v_add_f32 v166, v166, v86
    v_add_f32 v167, v167, v87
    ds_write_b128 v110, v[164:167] offset:32
    v_add_f32 v168, v168, v88
    v_add_f32 v169, v169, v89
    v_add_f32 v170, v170, v90
    v_add_f32 v171, v171, v91
    ds_write_b128 v110, v[168:171] offset:64
    v_add_f32 v172, v172, v92
    v_add_f32 v173, v173, v93
    v_add_f32 v174, v174, v94
    v_add_f32 v175, v175, v95
    ds_write_b128 v110, v[172:175] offset:96
    v_add_f32 v176, v176, v112
    v_add_f32 v177, v177, v113
    v_add_f32 v178, v178, v114
    v_add_f32 v179, v179, v115
    ds_write_b128 v110, v[176:179] offset:128
    v_add_f32 v180, v180, v116
    v_add_f32 v181, v181, v117
    v_add_f32 v182, v182, v118
    v_add_f32 v183, v183, v119
    ds_write_b128 v110, v[180:183] offset:160
    v_add_f32 v184, v184, v120
    v_add_f32 v185, v185, v121
    v_add_f32 v186, v186, v122
    v_add_f32 v187, v187, v123
    ds_write_b128 v110, v[184:187] offset:192
    v_add_f32 v188, v188, v124
    v_add_f32 v189, v189, v125
    v_add_f32 v190, v190, v126
    v_add_f32 v191, v191, v127
    ds_write_b128 v110, v[188:191] offset:224
    s_waitcnt lgkmcnt(0)
    s_barrier
    ds_read_b128 v[48:51], v111 offset:0
    ds_read_b128 v[52:55], v111 offset:128
    ds_read_b128 v[56:59], v111 offset:17408
    ds_read_b128 v[60:63], v111 offset:17536
    ds_read_b128 v[64:67], v111 offset:34816
    ds_read_b128 v[68:71], v111 offset:34944
    ds_read_b128 v[72:75], v111 offset:52224
    ds_read_b128 v[76:79], v111 offset:52352
    s_waitcnt lgkmcnt(6)
    v_add_f32 v128, v128, v48
    v_add_f32 v129, v129, v49
    v_add_f32 v130, v130, v50
    v_add_f32 v131, v131, v51
    v_add_f32 v132, v132, v52
    v_add_f32 v133, v133, v53
    v_add_f32 v134, v134, v54
    v_add_f32 v135, v135, v55
    s_waitcnt lgkmcnt(4)
    v_add_f32 v128, v128, v56
    v_add_f32 v129, v129, v57
    v_add_f32 v130, v130, v58
    v_add_f32 v131, v131, v59
    v_add_f32 v132, v132, v60
    v_add_f32 v133, v133, v61
    v_add_f32 v134, v134, v62
    v_add_f32 v135, v135, v63
    s_waitcnt lgkmcnt(2)
    v_add_f32 v128, v128, v64
    v_add_f32 v129, v129, v65
    v_add_f32 v130, v130, v66
    v_add_f32 v131, v131, v67
    v_add_f32 v132, v132, v68
    v_add_f32 v133, v133, v69
    v_add_f32 v134, v134, v70
    v_add_f32 v135, v135, v71
    s_waitcnt lgkmcnt(0)
    v_add_f32 v128, v128, v72
    v_add_f32 v129, v129, v73
    v_add_f32 v130, v130, v74
    v_add_f32 v131, v131, v75
    v_add_f32 v132, v132, v76
    v_add_f32 v133, v133, v77
    v_add_f32 v134, v134, v78
    v_add_f32 v135, v135, v79
    v_cvt_pk_bf16_f32 v36, v128, v132
    v_cvt_pk_bf16_f32 v37, v129, v133
    v_cvt_pk_bf16_f32 v38, v130, v134
    v_cvt_pk_bf16_f32 v39, v131, v135
    buffer_store_dwordx4 v[36:39], v5, s[8:11], s89 offen
K_exit:
    s_endpgm
K2_rs0:
    buffer_load_dwordx4 v[48:51], v10, s[20:23], s87 offen offset:0 sc1
    buffer_load_dwordx4 v[52:55], v10, s[20:23], s87 offen offset:1024 sc1
    buffer_load_dwordx4 v[56:59], v10, s[20:23], s87 offen offset:2048 sc1
    buffer_load_dwordx4 v[60:63], v10, s[20:23], s87 offen offset:3072 sc1
    s_branch K2_ri0
K2_rs1:
    buffer_load_dwordx4 v[12:15], v10, s[20:23], s88 offen offset:0 sc1
    buffer_load_dwordx4 v[16:19], v10, s[20:23], s88 offen offset:1024 sc1
    buffer_load_dwordx4 v[20:23], v10, s[20:23], s88 offen offset:2048 sc1
    buffer_load_dwordx4 v[24:27], v10, s[20:23], s88 offen offset:3072 sc1
    s_branch K2_ri1
K2_c3in:
    s_mov_b32 s94, 2097152
    v_mov_b32 v109, 34816
K2_c3:
    ds_read_b32 v108, v109
    s_waitcnt lgkmcnt(0)
    v_readfirstlane_b32 s73, v108
    s_nop 0
    s_bitcmp1_b32 s73, 27
    s_cbranch_scc1 K2_c3_ok
    s_sleep 1
    s_sub_u32 s94, s94, 1
    s_cbranch_scc0 K2_c3
K2_c3_ok:
    s_branch K2_loop
K2_fallback:
    s_mov_b32 s96, 1
    s_mov_b32 s95, 32
    v_subrev_u32 v2, 0x8000, v2
    v_lshlrev_b32 v108, 3, v4
    v_sub_u32 v3, v3, v108
    v_mov_b32 v108, 0xff800000
    v_mov_b32 v110, 0xff800000
    s_waitcnt lgkmcnt(0)
K2_fbloop:
    ds_read_b128 v[12:15], v2
    v_add_u32 v2, 1024, v2
    s_waitcnt lgkmcnt(0)
    v_mfma_f32_32x32x16_bf16 v[48:63], v[12:15], v[100:103], 0
    v_mfma_f32_32x32x16_bf16 v[64:79], v[12:15], v[104:107], 0
    s_nop 10
    v_max3_f32 v108, v108, v48, v49
    v_max3_f32 v108, v108, v50, v51
    v_max3_f32 v108, v108, v52, v53
    v_max3_f32 v108, v108, v54, v55
    v_max3_f32 v108, v108, v56, v57
    v_max3_f32 v108, v108, v58, v59
    v_max3_f32 v108, v108, v60, v61
    v_max3_f32 v108, v108, v62, v63
    v_max3_f32 v110, v110, v64, v65
    v_max3_f32 v110, v110, v66, v67
    v_max3_f32 v110, v110, v68, v69
    v_max3_f32 v110, v110, v70, v71
    v_max3_f32 v110, v110, v72, v73
    v_max3_f32 v110, v110, v74, v75
    v_max3_f32 v110, v110, v76, v77
    v_max3_f32 v110, v110, v78, v79
    s_sub_u32 s95, s95, 1
    s_cmp_lg_u32 s95, 0
    s_cbranch_scc1 K2_fbloop
    v_subrev_u32 v2, 0x8000, v2
    ds_read_b128 v[12:15], v2
    ds_read_b128 v[16:19], v2 offset:1024
    v_mov_b32 v80, 0
    v_mov_b32 v112, 0
    v_mov_b32 v81, 0
    v_mov_b32 v113, 0
    v_mov_b32 v82, 0
    v_mov_b32 v114, 0
    v_mov_b32 v83, 0
    v_mov_b32 v115, 0
    v_mov_b32 v84, 0
    v_mov_b32 v116, 0
    v_mov_b32 v85, 0
    v_mov_b32 v117, 0
    v_mov_b32 v86, 0
    v_mov_b32 v118, 0
    v_mov_b32 v87, 0
    v_mov_b32 v119, 0
    v_mov_b32 v88, 0
    v_mov_b32 v120, 0
    v_mov_b32 v40, 0
    v_mov_b32 v41, 0
    v_mov_b32 v42, 0
    v_mov_b32 v43, 0
    v_mov_b32 v32, 0
    v_mov_b32 v33, 0
    v_mov_b32 v34, 0
    v_mov_b32 v35, 0
    s_waitcnt lgkmcnt(0)
    s_branch K2_restart
.section .rodata,"a"
.p2align 6
.amdhsa_kernel parallel_sum__softmax_full_mha__glu_gated_geglu__prompt_kernel
  .amdhsa_next_free_vgpr 256
  .amdhsa_next_free_sgpr 102
  .amdhsa_accum_offset 256
  .amdhsa_group_segment_fixed_size 0
  .amdhsa_kernarg_size 80
  .amdhsa_user_sgpr_count 2
  .amdhsa_user_sgpr_kernarg_segment_ptr 1
  .amdhsa_system_sgpr_workgroup_id_x 1
.end_amdhsa_kernel
```
